```python
import torch

def _softmax(x, axis=-1):
    return torch.softmax(x, dim=axis)
def _gelu(x):
    return torch.nn.functional.gelu(x, approximate="tanh")
def _silu(x):
    return torch.nn.functional.silu(x)
def _sigmoid(x):
    return torch.sigmoid(x)
def _layernorm(x, axis=-1, eps=1e-5):
    m = x.mean(dim=axis, keepdim=True)
    v = x.var(dim=axis, keepdim=True, unbiased=False)
    return (x - m) / torch.sqrt(v + eps)
def _scatter_add(tgt, idx, src, axis=0):
    return tgt.clone().index_add_(axis, idx, src)
def _segment_sum(src, seg, n):
    out = torch.zeros((n,) + src.shape[1:], dtype=src.dtype)
    return out.index_add_(0, seg, src)
def _pad(x, pw):
    flat = tuple(v for pair in reversed(pw) for v in pair)
    return torch.nn.functional.pad(x, flat)

kernel_name = 'interleave_layers__sliding_block_cached__glu_gated_glu__decode'

def setup_inputs():

    _w = (lambda a: (lambda t: t.to(torch.bfloat16) if t.is_floating_point() else t)(torch.as_tensor(a)))
    def _A_setup():
        B, Sq, D = 1, 1, 512
        Hq, Hkv, Sk, Dh = 32, 8, 32768, 128
        assert Hq % Hkv == 0, (Hq, Hkv)
        return {
            "x": _w((lambda *s: torch.randn(*s, dtype=torch.bfloat16) * 0.05)(B, Sq, D)),
            "k_cache": _w((lambda *s: torch.randn(*s, dtype=torch.bfloat16) * 1.6)(B, Hkv, Sk, Dh)),
            "v_cache": _w((lambda *s: torch.randn(*s, dtype=torch.bfloat16) * 1.6)(B, Hkv, Sk, Dh)),
            "wq": _w((lambda *s: torch.randn(*s, dtype=torch.bfloat16) * 1.6)(D, Hq * Dh) * (D ** -0.5)),
            "wo": _w((lambda *s: torch.randn(*s, dtype=torch.bfloat16) * 1.6)(Hq * Dh, D) * ((Hq * Dh) ** -0.5)),
        }
    _A_in = _A_setup()

    def _B_setup():
        B, S, D, F = 1, 1, 512, 1792
        return {
            "x": _w((lambda *s: torch.randn(*s, dtype=torch.bfloat16) * 0.05)(B, S, D)),
            "w_gate": _w((lambda *s: torch.randn(*s, dtype=torch.bfloat16) * 0.05)(D, F)),
            "w_up": _w((lambda *s: torch.randn(*s, dtype=torch.bfloat16) * 0.05)(D, F)),
            "w_down": _w((lambda *s: torch.randn(*s, dtype=torch.bfloat16) * 0.05)(F, D)),
        }
    _B_in = _B_setup()

    return {
        "A_x": _A_in["x"],
        "A_k_cache": _A_in["k_cache"],
        "A_v_cache": _A_in["v_cache"],
        "A_wq": _A_in["wq"],
        "A_wo": _A_in["wo"],
        "B_x": _B_in["x"],
        "B_w_gate": _B_in["w_gate"],
        "B_w_up": _B_in["w_up"],
        "B_w_down": _B_in["w_down"],
    }

def reference(A_x, A_k_cache, A_v_cache, A_wq, A_wo, B_x, B_w_gate, B_w_up, B_w_down):
    def _A_ref(x, k_cache, v_cache, wq, wo):
        B, Sq, D = x.shape
        Hq, Dh = 32, 128
        Hkv, Sk = k_cache.shape[1], k_cache.shape[2]
        W = min(4096, max(256, Sk // 4))
        rep = Hq // Hkv
        q = (lambda x, *d: x.permute(*d))((x @ wq).reshape(B, Sq, Hq, Dh), 0, 2, 1, 3)
        k = (lambda x, n, axis: torch.repeat_interleave(x, n, dim=axis))(k_cache[:, :, Sk - W:, :], rep, axis=1)
        v = (lambda x, n, axis: torch.repeat_interleave(x, n, dim=axis))(v_cache[:, :, Sk - W:, :], rep, axis=1)
        scores = torch.einsum("bhqd,bhkd->bhqk", q, k) * (Dh ** -0.5)
        p = _softmax(scores, axis=-1)
        o = torch.einsum("bhqk,bhkd->bhqd", p, v)
        return (lambda x, *d: x.permute(*d))(o, 0, 2, 1, 3).reshape(B, Sq, Hq * Dh) @ wo

    def _B_ref(x, w_gate, w_up, w_down):
        g = torch.einsum("bsd,df->bsf", x, w_gate)
        u = torch.einsum("bsd,df->bsf", x, w_up)
        h = _sigmoid(g) * u
        return torch.einsum("bsf,fd->bsd", h, w_down)

    x = A_x
    x = x + _A_ref(_layernorm(x, axis=-1), A_k_cache, A_v_cache, A_wq, A_wo)
    x = x + _B_ref(_layernorm(x, axis=-1), B_w_gate, B_w_up, B_w_down)
    x = x + _A_ref(_layernorm(x, axis=-1), A_k_cache, A_v_cache, A_wq, A_wo)
    x = x + _B_ref(_layernorm(x, axis=-1), B_w_gate, B_w_up, B_w_down)
    return x
```

```asm
; @launch grid=(256,1,1) block=(576,1,1) lds=131072
.amdgcn_target "amdgcn-amd-amdhsa--gfx950"
.text
.globl interleave_layers__sliding_block_cached__glu_gated_glu__decode_kernel
.p2align 8
.type interleave_layers__sliding_block_cached__glu_gated_glu__decode_kernel,@function
interleave_layers__sliding_block_cached__glu_gated_glu__decode_kernel:
    s_cmp_ge_u32 s2, 256
    s_cbranch_scc1 L_end
    s_load_dwordx16 s[4:19], s[0:1], 0
    s_load_dwordx8 s[20:27], s[0:1], 64
    v_lshrrev_b32 v3, 6, v0
    s_and_b32 s28, s2, 7
    s_lshr_b32 s29, s2, 3
    v_readfirstlane_b32 s30, v3
    s_nop 0
    s_cmp_eq_u32 s30, 8
    s_cbranch_scc1 L_D
    s_cmp_gt_u32 s30, 4
    s_cbranch_scc1 L_G
    s_cmp_lt_u32 s30, 4
    s_cbranch_scc1 L_M
    s_and_b32 s32, s29, 7
    s_lshr_b32 s33, s29, 3
    v_and_b32 v0, 63, v0
    s_and_b32 s38, s30, 3
    v_and_b32 v1, 15, v0
    v_lshrrev_b32 v2, 4, v0
    s_lshl_b32 s54, s33, 20
    s_lshl_b32 s55, s30, 17
    s_add_u32 s54, s54, s55
    s_lshl_b32 s55, s28, 10
    s_add_u32 s54, s54, s55
    s_lshl_b32 s55, s32, 7
    s_add_u32 s54, s54, s55
    v_and_b32 v4, 7, v0
    v_bfe_u32 v28, v0, 4, 1
    v_lshlrev_b32 v28, 1, v28
    v_xor_b32 v4, v4, v28
    v_lshlrev_b32 v4, 4, v4
    v_lshrrev_b32 v3, 3, v0
    v_lshl_add_u32 v28, v3, 13, v4
    v_xor_b32 v29, 64, v28
    v_add_u32 v29, 0x10000, v29
    s_lshl_b32 s53, s30, 11
    s_add_u32 s53, s53, 8192
    s_mov_b32 m0, s53
    s_mul_i32 s56, s28, 124928
    s_add_u32 s56, s56, 196608
    s_mul_i32 s57, s28, 9472
    s_add_u32 s57, s57, 1196032
    v_and_b32 v4, 7, v0
    v_lshl_add_u32 v3, v4, 2, v2
    s_lshl_b32 s52, s38, 5
    v_add_u32 v3, s52, v3
    v_lshlrev_b32 v11, 1, v3
    s_lshl_b32 s52, s33, 8
    v_add_u32 v3, s52, v11
    v_lshlrev_b32 v31, 4, v0
    v_mov_b32 v25, 0
    s_waitcnt lgkmcnt(0)
    s_add_u32 s54, s10, s54
    s_addc_u32 s55, s11, 0
    global_load_dword v25, v25, s[26:27] offset:0 sc1
    s_cmp_lg_u32 s38, 0
    s_cbranch_scc1 L_sb_58
    global_load_dwordx4 v[120:123], v31, s[4:5]
L_sb_58:
    global_load_ushort v24, v3, s[4:5]
    global_load_lds_dwordx4 v28, s[54:55] nt
    s_add_u32 m0, s53, 1024
    s_nop 0
    global_load_lds_dwordx4 v29, s[54:55] nt
    s_memrealtime s[62:63]
    s_mov_b32 s45, 0xffff0000
    s_cmp_ge_u32 s38, 1
    s_cbranch_scc1 L_GS
    s_cmp_eq_u32 s38, 0
    s_cselect_b64 exec, -1, 0
    s_cbranch_scc0 L_GN
    s_waitcnt vmcnt(3)
L_GN:
    s_mov_b32 s52, 0x3f803f80
    v_dot2_f32_bf16 v124, v120, s52, 0
    v_dot2_f32_bf16 v125, v120, v120, 0
    v_dot2_f32_bf16 v124, v121, s52, v124
    v_dot2_f32_bf16 v125, v121, v121, v125
    v_dot2_f32_bf16 v124, v122, s52, v124
    v_dot2_f32_bf16 v125, v122, v122, v125
    v_dot2_f32_bf16 v124, v123, s52, v124
    v_dot2_f32_bf16 v125, v123, v123, v125
    s_nop 1
    v_add_f32_dpp v124, v124, v124 quad_perm:[1,0,3,2] row_mask:0xf bank_mask:0xf
    v_add_f32_dpp v125, v125, v125 quad_perm:[1,0,3,2] row_mask:0xf bank_mask:0xf
    s_nop 0
    v_add_f32_dpp v124, v124, v124 quad_perm:[2,3,0,1] row_mask:0xf bank_mask:0xf
    v_add_f32_dpp v125, v125, v125 quad_perm:[2,3,0,1] row_mask:0xf bank_mask:0xf
    s_nop 0
    v_add_f32_dpp v124, v124, v124 row_half_mirror row_mask:0xf bank_mask:0xf
    v_add_f32_dpp v125, v125, v125 row_half_mirror row_mask:0xf bank_mask:0xf
    s_nop 0
    v_add_f32_dpp v124, v124, v124 row_mirror row_mask:0xf bank_mask:0xf
    v_add_f32_dpp v125, v125, v125 row_mirror row_mask:0xf bank_mask:0xf
    v_mov_b32 v126, v124
    s_nop 1
    v_permlane16_swap_b32 v124, v126
    v_add_f32 v124, v124, v126
    v_mov_b32 v126, v125
    s_nop 1
    v_permlane16_swap_b32 v125, v126
    v_add_f32 v125, v125, v126
    v_mov_b32 v126, v124
    s_nop 1
    v_permlane32_swap_b32 v124, v126
    v_add_f32 v124, v124, v126
    v_mov_b32 v126, v125
    s_nop 1
    v_permlane32_swap_b32 v125, v126
    v_add_f32 v125, v125, v126
    v_mul_f32 v124, 0x3b000000, v124
    v_mul_f32 v125, 0x3b000000, v125
    v_fma_f32 v125, -v124, v124, v125
    v_max_f32 v125, 0, v125
    v_cvt_pk_bf16_f32 v126, v124, v125
    v_and_b32 v125, s45, v126
    v_add_f32 v125, 0x3727c5ac, v125
    v_lshlrev_b32 v124, 16, v126
    v_cvt_pk_bf16_f32 v125, v125, v125
    v_lshlrev_b32 v125, 16, v125
    v_sqrt_f32 v125, v125
    s_nop 0
    v_cvt_pk_bf16_f32 v125, v125, v125
    v_lshlrev_b32 v125, 16, v125
    v_rcp_f32 v125, v125
    v_lshlrev_b32 v126, 16, v120
    v_and_b32 v127, s45, v120
    v_sub_f32 v126, v126, v124
    v_sub_f32 v127, v127, v124
    v_cvt_pk_bf16_f32 v126, v126, v127
    v_and_b32 v127, s45, v126
    v_lshlrev_b32 v126, 16, v126
    v_mul_f32 v126, v126, v125
    v_mul_f32 v127, v127, v125
    v_cvt_pk_bf16_f32 v120, v126, v127
    v_lshlrev_b32 v126, 16, v121
    v_and_b32 v127, s45, v121
    v_sub_f32 v126, v126, v124
    v_sub_f32 v127, v127, v124
    v_cvt_pk_bf16_f32 v126, v126, v127
    v_and_b32 v127, s45, v126
    v_lshlrev_b32 v126, 16, v126
    v_mul_f32 v126, v126, v125
    v_mul_f32 v127, v127, v125
    v_cvt_pk_bf16_f32 v121, v126, v127
    v_lshlrev_b32 v126, 16, v122
    v_and_b32 v127, s45, v122
    v_sub_f32 v126, v126, v124
    v_sub_f32 v127, v127, v124
    v_cvt_pk_bf16_f32 v126, v126, v127
    v_and_b32 v127, s45, v126
    v_lshlrev_b32 v126, 16, v126
    v_mul_f32 v126, v126, v125
    v_mul_f32 v127, v127, v125
    v_cvt_pk_bf16_f32 v122, v126, v127
    v_lshlrev_b32 v126, 16, v123
    v_and_b32 v127, s45, v123
    v_sub_f32 v126, v126, v124
    v_sub_f32 v127, v127, v124
    v_cvt_pk_bf16_f32 v126, v126, v127
    v_and_b32 v127, s45, v126
    v_lshlrev_b32 v126, 16, v126
    v_mul_f32 v126, v126, v125
    v_mul_f32 v127, v127, v125
    v_cvt_pk_bf16_f32 v123, v126, v127
    v_cmp_eq_u32 vcc, s33, v2
    v_lshlrev_b32 v3, 4, v1
    s_and_b64 exec, exec, vcc
    ds_write_b128 v3, v[120:123] offset:0
    s_mov_b64 exec, -1
    s_cmp_lg_u32 s38, 0
    s_cbranch_scc1 L_GS
    s_waitcnt vmcnt(0) lgkmcnt(0)
    s_barrier
    s_branch L_GS
    s_nop 0
    s_nop 0
    s_nop 0
    s_nop 0
    s_nop 0
    s_nop 0
    s_nop 0
    s_nop 0
    s_nop 0
    s_nop 0
    s_nop 0
    s_nop 0
    s_nop 0
L_M:
    s_and_b32 s32, s29, 7
    s_lshr_b32 s33, s29, 3
    v_and_b32 v0, 63, v0
    s_and_b32 s38, s30, 3
    v_and_b32 v1, 15, v0
    v_lshrrev_b32 v2, 4, v0
    s_lshl_b32 s54, s33, 20
    s_lshl_b32 s55, s30, 17
    s_add_u32 s54, s54, s55
    s_lshl_b32 s55, s28, 10
    s_add_u32 s54, s54, s55
    s_lshl_b32 s55, s32, 7
    s_add_u32 s54, s54, s55
    v_and_b32 v4, 7, v0
    v_bfe_u32 v28, v0, 4, 1
    v_lshlrev_b32 v28, 1, v28
    v_xor_b32 v4, v4, v28
    v_lshlrev_b32 v4, 4, v4
    v_lshrrev_b32 v3, 3, v0
    v_lshl_add_u32 v28, v3, 13, v4
    v_xor_b32 v29, 64, v28
    v_add_u32 v29, 0x10000, v29
    s_lshl_b32 s53, s30, 11
    s_add_u32 s53, s53, 8192
    s_mov_b32 m0, s53
    s_mul_i32 s56, s28, 124928
    s_add_u32 s56, s56, 196608
    s_mul_i32 s57, s28, 9472
    s_add_u32 s57, s57, 1196032
    v_and_b32 v4, 7, v0
    v_lshl_add_u32 v3, v4, 2, v2
    s_lshl_b32 s52, s38, 5
    v_add_u32 v3, s52, v3
    v_lshlrev_b32 v11, 1, v3
    s_lshl_b32 s52, s33, 8
    v_add_u32 v3, s52, v11
    v_lshlrev_b32 v31, 4, v0
    v_mov_b32 v25, 0
    s_waitcnt lgkmcnt(0)
    s_add_u32 s54, s10, s54
    s_addc_u32 s55, s11, 0
    global_load_dword v25, v25, s[26:27] offset:0 sc1
    global_load_lds_dwordx4 v28, s[54:55] nt
    s_add_u32 m0, s53, 1024
    s_nop 0
    global_load_lds_dwordx4 v29, s[54:55] nt
    s_memrealtime s[62:63]
    s_add_u32 s34, s26, s56
    s_addc_u32 s35, s27, 0
    s_add_u32 s36, s26, s57
    s_addc_u32 s37, s27, 0
    s_add_u32 s40, s26, 65536
    s_addc_u32 s41, s27, 0
    s_mov_b32 s44, 0x3e0293ee
    s_mov_b32 s45, 0xffff0000
    s_mov_b32 s31, 0
    s_mov_b32 s43, 0
    s_movk_i32 s42, 0x400
    s_movk_i32 s39, 3584
    s_lshl_b32 s46, s28, 8
    s_movk_i32 s47, 64
    s_cmp_lt_u32 s28, 4
    s_cbranch_scc1 L_fr_1
    s_mul_i32 s46, s28, 192
    s_add_u32 s46, s46, 256
    s_movk_i32 s47, 48
L_fr_1:
    v_lshrrev_b32 v3, 2, v1
    v_lshlrev_b32 v3, 6, v3
    v_lshl_add_u32 v16, v2, 4, v3
    v_lshlrev_b32 v17, 4, v2
    v_mov_b32 v14, v17
    s_lshr_b32 s52, s30, 1
    s_lshl_b32 s52, s52, 11
    s_lshr_b32 s53, s29, 1
    s_lshl_b32 s53, s53, 7
    s_add_u32 s52, s52, s53
    s_and_b32 s53, s30, 1
    s_lshl_b32 s53, s53, 6
    s_add_u32 s52, s52, s53
    s_and_b32 s53, s29, 1
    s_lshl_b32 s53, s53, 1
    s_add_u32 s52, s52, s53
    v_lshlrev_b32 v3, 13, v2
    v_lshl_add_u32 v3, v1, 2, v3
    v_add_u32 v18, s52, v3
    v_bfe_u32 v3, v0, 2, 2
    v_lshl_add_u32 v4, v2, 3, v3
    v_lshrrev_b32 v3, 1, v3
    v_and_b32 v28, 1, v2
    v_lshl_add_u32 v3, v28, 1, v3
    v_xor_b32 v3, s38, v3
    v_bfe_u32 v28, v0, 1, 1
    v_lshl_add_u32 v3, v3, 1, v28
    v_lshlrev_b32 v3, 4, v3
    v_lshl_add_u32 v3, v4, 7, v3
    v_and_b32 v28, 1, v0
    v_lshl_add_u32 v19, v28, 3, v3
    s_lshl_b32 s52, s32, 12
    s_lshr_b32 s53, s38, 1
    s_lshl_b32 s53, s53, 11
    s_add_u32 s52, s52, s53
    s_lshl_b32 s53, s28, 8
    s_add_u32 s52, s52, s53
    s_lshr_b32 s53, s33, 1
    s_lshl_b32 s53, s53, 7
    s_add_u32 s52, s52, s53
    s_and_b32 s53, s33, 1
    s_lshl_b32 s53, s53, 1
    s_add_u32 s52, s52, s53
    s_and_b32 s53, s38, 1
    s_lshl_b32 s53, s53, 6
    s_add_u32 s52, s52, s53
    v_lshl_add_u32 v15, v1, 2, s52
    v_add_u32 v15, 32768, v15
    s_mov_b32 s59, 41984
    s_mov_b32 s48, s38
    s_lshl_b32 s52, s28, 23
    s_lshl_b32 s53, s29, 11
    s_add_u32 s52, s52, s53
    s_lshl_b32 s53, s38, 16
    s_add_u32 s52, s52, s53
    s_add_u32 s52, s52, 7340032
    s_add_u32 s56, s6, s52
    s_addc_u32 s57, s7, 0
    v_xor_b32 v3, v1, v2
    v_lshlrev_b32 v3, 4, v3
    v_lshl_add_u32 v144, v2, 8, v3
    v_xor_b32 v145, 64, v144
    v_xor_b32 v146, 128, v144
    v_xor_b32 v147, 192, v144
    s_lshl_b32 s52, s38, 13
    s_add_u32 s52, s52, 98304
    v_lshl_add_u32 v140, v1, 8, v3
    v_add_u32 v140, s52, v140
    v_xor_b32 v141, 64, v140
    v_xor_b32 v142, 128, v140
    v_xor_b32 v143, 192, v140
    v_bfe_u32 v3, v0, 3, 1
    v_bfe_u32 v4, v0, 2, 1
    v_lshl_add_u32 v28, v2, 2, v3
    v_lshl_add_u32 v28, v4, 4, v28
    v_lshl_add_u32 v3, v4, 1, v3
    v_and_b32 v4, 1, v2
    v_lshl_add_u32 v3, v4, 2, v3
    v_xor_b32 v3, s30, v3
    v_lshlrev_b32 v3, 5, v3
    v_lshl_add_u32 v3, v28, 8, v3
    v_and_b32 v4, 3, v0
    v_lshl_add_u32 v3, v4, 3, v3
    v_add_u32 v30, 65536, v3
    v_lshrrev_b32 v3, 2, v1
    v_mul_u32_u24 v3, 272, v3
    v_lshl_add_u32 v5, v2, 4, v3
    s_lshl_b32 s52, s38, 8
    s_add_u32 s52, s52, 2560
    v_lshl_add_u32 v6, v0, 2, s52
    s_mul_i32 s52, s33, 2304
    s_lshl_b32 s53, s32, 8
    s_add_u32 s52, s52, s53
    s_lshl_b32 s53, s38, 6
    s_add_u32 s52, s52, s53
    v_lshl_add_u32 v7, v1, 2, s52
    s_lshr_b32 s52, s33, 1
    s_mul_i32 s52, s52, 2304
    s_lshl_b32 s53, s32, 8
    s_add_u32 s52, s52, s53
    s_lshl_b32 s53, s38, 6
    s_add_u32 s52, s52, s53
    s_and_b32 s53, s33, 1
    s_lshl_b32 s53, s53, 1
    s_add_u32 s52, s52, s53
    s_add_u32 s52, s52, 32768
    v_lshl_add_u32 v11, v1, 2, s52
    v_cmp_lt_u32 vcc, 7, v1
    v_mov_b32 v3, 1024
    s_nop 0
    v_cndmask_b32 v3, 0, v3, vcc
    v_add_u32 v8, v3, v14
    s_bfe_u32 s52, s29, 0x30001
    s_lshl_b32 s52, s52, 4
    s_lshr_b32 s53, s29, 4
    s_lshl_b32 s53, s53, 3
    s_add_u32 s52, s52, s53
    s_and_b32 s53, s29, 1
    s_lshl_b32 s53, s53, 2
    s_add_u32 s52, s52, s53
    s_add_u32 s52, s52, 51200
    v_lshlrev_b32 v3, 7, v2
    v_lshl_add_u32 v3, v1, 9, v3
    v_add_u32 v9, s52, v3
    s_waitcnt vmcnt(0)
    s_lshl_b32 s52, s38, 13
    s_add_u32 s52, s52, 98304
    s_add_u32 m0, s52, 0
    s_nop 0
    global_load_lds_dwordx4 v144, s[56:57] offset:0 nt
    global_load_lds_dwordx4 v145, s[56:57] offset:1024 nt
    s_add_u32 s56, s56, 262144
    s_addc_u32 s57, s57, 0
    s_add_u32 m0, s52, 2048
    s_nop 0
    global_load_lds_dwordx4 v146, s[56:57] offset:0 nt
    global_load_lds_dwordx4 v147, s[56:57] offset:1024 nt
    s_waitcnt lgkmcnt(0)
    v_readfirstlane_b32 s60, v25
    s_nop 0
    s_add_u32 s60, s60, 1
    s_and_b32 s61, s60, 0xff
L_Mloop:
    s_barrier
    s_cmp_lg_u32 s43, 0
    s_cbranch_scc1 L_q1_2
    ds_read_b64_tr_b16 v[32:33], v19 offset:8192
    ds_read_b64_tr_b16 v[34:35], v19 offset:8704
    ds_read_b64_tr_b16 v[36:37], v19 offset:12288
    ds_read_b64_tr_b16 v[38:39], v19 offset:12800
    ds_read_b64_tr_b16 v[40:41], v19 offset:16384
    ds_read_b64_tr_b16 v[42:43], v19 offset:16896
    ds_read_b64_tr_b16 v[44:45], v19 offset:20480
    ds_read_b64_tr_b16 v[46:47], v19 offset:20992
    ds_read_b128 v[124:127], v8 offset:0
    ds_read_b128 v[128:131], v8 offset:64
    ds_read_b128 v[132:135], v8 offset:128
    ds_read_b128 v[136:139], v8 offset:192
    v_mov_b32 v3, 0xffffff00
    s_lshl_b32 s52, s38, 6
    s_add_u32 s52, s52, 4672
    v_lshl_add_u32 v4, v1, 2, s52
    s_waitcnt lgkmcnt(3)
    v_mfma_f32_16x16x32_bf16 v[120:123], v[124:127], v[32:35], 0
    s_waitcnt lgkmcnt(2)
    v_mfma_f32_16x16x32_bf16 v[120:123], v[128:131], v[36:39], v[120:123]
    s_waitcnt lgkmcnt(1)
    v_mfma_f32_16x16x32_bf16 v[120:123], v[132:135], v[40:43], v[120:123]
    s_waitcnt lgkmcnt(0)
    v_mfma_f32_16x16x32_bf16 v[120:123], v[136:139], v[44:47], v[120:123]
    s_nop 7
    v_mov_b32 v10, v120
    v_and_or_b32 v120, v120, v3, s61
    s_mov_b64 exec, 0xffff
    global_store_dword v7, v120, s[36:37]
    ds_write_b32 v4, v120
    s_mov_b64 exec, -1
    s_lshl_b32 s52, s38, 13
    s_add_u32 s52, s52, 98304
    s_add_u32 s56, s56, 262144
    s_addc_u32 s57, s57, 0
    s_add_u32 m0, s52, 4096
    s_nop 0
    global_load_lds_dwordx4 v144, s[56:57] offset:0 nt
    global_load_lds_dwordx4 v145, s[56:57] offset:1024 nt
    s_add_u32 s56, s56, 262144
    s_addc_u32 s57, s57, 0
    s_add_u32 m0, s52, 6144
    s_nop 0
    global_load_lds_dwordx4 v146, s[56:57] offset:0 nt
    global_load_lds_dwordx4 v147, s[56:57] offset:1024 nt
    s_waitcnt lgkmcnt(0)
    v_mov_b32 v28, 4932
    v_mov_b32 v29, 1
    s_mov_b64 exec, 1
    ds_add_u32 v28, v29
    s_mov_b64 exec, -1
    s_and_b32 s52, s29, 7
    s_lshl_b32 s53, s38, 3
    s_add_u32 s52, s52, s53
    s_mov_b32 s53, 1
    s_mov_b32 s98, 0
    s_mov_b64 exec, 0
    s_branch L_TENT
L_TRET0:
    s_mov_b64 exec, -1
    s_waitcnt vmcnt(0)
    ds_read_b128 v[72:75], v140 offset:0
    ds_read_b128 v[76:79], v141 offset:0
    ds_read_b128 v[80:83], v142 offset:0
    ds_read_b128 v[84:87], v143 offset:0
    ds_read_b128 v[88:91], v140 offset:4096
    ds_read_b128 v[92:95], v141 offset:4096
    ds_read_b128 v[96:99], v142 offset:4096
    ds_read_b128 v[100:103], v143 offset:4096
    s_branch L_q2_3
L_q1_2:
L_TP0:
    s_cbranch_execz L_TX0
    ds_read_b128 v[124:127], v14 offset:0
    ds_read_b128 v[128:131], v14 offset:64
    ds_read_b128 v[132:135], v14 offset:128
    ds_read_b128 v[136:139], v14 offset:192
L_TP1:
    s_cbranch_execz L_TX1
    s_waitcnt lgkmcnt(3)
    v_mfma_f32_16x16x32_bf16 v[120:123], v[124:127], v[32:35], 0
    s_waitcnt lgkmcnt(2)
    v_mfma_f32_16x16x32_bf16 v[120:123], v[128:131], v[36:39], v[120:123]
    s_waitcnt lgkmcnt(1)
    v_mfma_f32_16x16x32_bf16 v[120:123], v[132:135], v[40:43], v[120:123]
    s_waitcnt lgkmcnt(0)
    v_mfma_f32_16x16x32_bf16 v[120:123], v[136:139], v[44:47], v[120:123]
    s_mov_b64 exec, 0xffff
L_TP2:
    s_cbranch_execz L_TX2
    s_nop 6
    v_cvt_pk_bf16_f32 v120, v120, v120
    s_cmp_eq_u32 s31, 0
    s_cbranch_scc1 L_st_4
    global_store_short v11, v120, s[34:35]
    s_branch L_st_5
L_st_4:
    global_store_short v11, v120, s[34:35] sc1
L_st_5:
    s_mov_b64 exec, -1
L_q2_3:
    s_cmp_lg_u32 s43, 0
    s_cbranch_scc1 L_sy_6
    v_mov_b32 v28, 4952
    s_mov_b32 s65, 0x100000
L_lw_8:
    s_sub_u32 s65, s65, 1
    s_cbranch_scc1 L_lwd_9
    ds_read_b32 v29, v28
    s_waitcnt lgkmcnt(0)
    v_readfirstlane_b32 s52, v29
    s_nop 0
    s_cmp_lg_u32 s52, 4
    s_cbranch_scc1 L_lw_8
L_lwd_9:
    s_branch L_sy_7
L_sy_6:
    s_waitcnt lgkmcnt(0)
    s_barrier
L_sy_7:
    ds_read_b128 v[136:139], v5 offset:1280
    ds_read_b128 v[140:143], v5 offset:1344
    ds_read_b128 v[144:147], v5 offset:1408
    ds_read_b128 v[148:151], v5 offset:1472
    v_mov_b32 v3, 2368
    ds_read_b64 v[152:153], v3
    s_waitcnt lgkmcnt(4)
    v_mfma_f32_16x16x32_bf16 v[128:131], v[136:139], v[72:75], 0
    v_mfma_f32_16x16x32_bf16 v[132:135], v[136:139], v[88:91], 0
    s_waitcnt lgkmcnt(3)
    v_mfma_f32_16x16x32_bf16 v[128:131], v[140:143], v[76:79], v[128:131]
    v_mfma_f32_16x16x32_bf16 v[132:135], v[140:143], v[92:95], v[132:135]
    s_waitcnt lgkmcnt(2)
    v_mfma_f32_16x16x32_bf16 v[128:131], v[144:147], v[80:83], v[128:131]
    v_mfma_f32_16x16x32_bf16 v[132:135], v[144:147], v[96:99], v[132:135]
    s_waitcnt lgkmcnt(1)
    v_mfma_f32_16x16x32_bf16 v[128:131], v[148:151], v[84:87], v[128:131]
    v_mfma_f32_16x16x32_bf16 v[132:135], v[148:151], v[100:103], v[132:135]
    s_waitcnt lgkmcnt(0)
    s_cmp_lg_u32 s43, 0
    s_cbranch_scc1 L_r0_10
    v_mov_b32 v153, s44
    s_branch L_r1_11
L_r0_10:
L_TP3:
    s_cbranch_execz L_TX3
    v_mul_f32 v152, 0x3b000000, v152
    v_mul_f32 v153, 0x3b000000, v153
    v_fma_f32 v153, -v152, v152, v153
    v_max_f32 v153, 0, v153
    v_cvt_pk_bf16_f32 v154, v152, v153
    v_and_b32 v153, s45, v154
    v_add_f32 v153, 0x3727c5ac, v153
L_TP4:
    s_cbranch_execz L_TX4
    v_lshlrev_b32 v152, 16, v154
    v_cvt_pk_bf16_f32 v153, v153, v153
    v_lshlrev_b32 v153, 16, v153
    v_sqrt_f32 v153, v153
    s_nop 0
    v_cvt_pk_bf16_f32 v153, v153, v153
    v_lshlrev_b32 v153, 16, v153
    v_rcp_f32 v153, v153
    s_nop 0
    v_mul_f32 v153, s44, v153
L_r1_11:
    v_max_f32 v3, v128, v132
    s_nop 1
    v_max_f32_dpp v3, v3, v3 quad_perm:[1,0,3,2] row_mask:0xf bank_mask:0xf
    s_nop 1
    v_max_f32_dpp v3, v3, v3 quad_perm:[2,3,0,1] row_mask:0xf bank_mask:0xf
    s_nop 1
    v_max_f32_dpp v3, v3, v3 row_half_mirror row_mask:0xf bank_mask:0xf
    s_nop 1
    v_max_f32_dpp v3, v3, v3 row_mirror row_mask:0xf bank_mask:0xf
    v_mul_f32 v3, v153, v3
    v_fma_f32 v128, v128, v153, -v3
    v_fma_f32 v132, v132, v153, -v3
    v_exp_f32 v128, v128
    v_exp_f32 v132, v132
    s_lshl_b32 s52, s38, 2
    s_add_u32 s52, s52, 4608
    v_add_u32 v4, s52, v17
    ds_write_b32 v4, v3
    v_cvt_pk_bf16_f32 v129, v128, v132
    v_add_f32 v130, v128, v132
    ds_write2st64_b32 v6, v129, v130 offset0:0 offset1:4
    s_cmp_lg_u32 s43, 0
    s_cbranch_scc1 L_sy_12
    v_mov_b32 v28, 4956
    v_mov_b32 v29, 1
    s_mov_b64 exec, 1
    ds_add_u32 v28, v29
    s_mov_b64 exec, -1
    v_mov_b32 v28, 4956
    s_mov_b32 s65, 0x100000
L_lw_14:
    s_sub_u32 s65, s65, 1
    s_cbranch_scc1 L_lwd_15
    ds_read_b32 v29, v28
    s_waitcnt lgkmcnt(0)
    v_readfirstlane_b32 s52, v29
    s_nop 0
    s_cmp_lg_u32 s52, 8
    s_cbranch_scc1 L_lw_14
L_lwd_15:
    s_branch L_sy_13
L_sy_12:
    s_waitcnt lgkmcnt(0)
    s_barrier
L_sy_13:
    s_cmp_lg_u32 s43, 0
    s_cbranch_scc1 L_l0_16
    v_mov_b32 v3, 4928
    ds_read_b32 v21, v3
    ds_read_b64_tr_b16 v[104:105], v30 offset:0
    ds_read_b64_tr_b16 v[106:107], v30 offset:512
    ds_read_b64_tr_b16 v[108:109], v30 offset:8192
    ds_read_b64_tr_b16 v[110:111], v30 offset:8704
    ds_read_b64_tr_b16 v[112:113], v30 offset:16384
    ds_read_b64_tr_b16 v[114:115], v30 offset:16896
    ds_read_b64_tr_b16 v[116:117], v30 offset:24576
    ds_read_b64_tr_b16 v[118:119], v30 offset:25088
L_l0_16:
    ds_read_b128 v[120:123], v16 offset:2560
    ds_read_b128 v[124:127], v16 offset:2816
    ds_read_b128 v[128:131], v16 offset:3072
    ds_read_b128 v[132:135], v16 offset:3328
    ds_read_b128 v[136:139], v17 offset:4608
    s_cmp_lg_u32 s48, 0
    s_cbranch_scc1 L_mo_17
    ds_read2st64_b32 v[156:157], v6 offset0:4 offset1:5
    ds_read2st64_b32 v[158:159], v6 offset0:6 offset1:7
L_mo_17:
    s_waitcnt lgkmcnt(0)
    v_readfirstlane_b32 s31, v21
    v_mfma_f32_16x16x32_bf16 v[140:143], v[120:123], v[104:107], 0
    v_mfma_f32_16x16x32_bf16 v[144:147], v[124:127], v[108:111], 0
    v_mfma_f32_16x16x32_bf16 v[148:151], v[128:131], v[112:115], 0
    v_mfma_f32_16x16x32_bf16 v[152:155], v[132:135], v[116:119], 0
    v_max3_f32 v3, v136, v137, v138
    v_max_f32 v3, v3, v139
    s_cmp_lg_u32 s48, 0
    s_cbranch_scc1 L_mo_18
    s_mov_b32 exec_lo, 0x00010001
    s_mov_b32 exec_hi, 0x00010001
    s_cmp_eq_u32 s31, 0
    s_cbranch_scc1 L_st_19
    global_store_dword v9, v3, s[34:35]
    s_branch L_st_20
L_st_19:
    global_store_dword v9, v3, s[34:35] sc1
L_st_20:
    s_mov_b64 exec, -1
L_mo_18:
    v_sub_f32 v136, v136, v3
    v_sub_f32 v137, v137, v3
    v_sub_f32 v138, v138, v3
    v_sub_f32 v139, v139, v3
    v_exp_f32 v136, v136
    v_exp_f32 v137, v137
    v_exp_f32 v138, v138
    v_exp_f32 v139, v139
    v_mul_f32 v4, v136, v140
    v_fmac_f32 v4, v137, v144
    v_fmac_f32 v4, v138, v148
    v_fmac_f32 v4, v139, v152
    v_cvt_pk_bf16_f32 v4, v4, v4
    s_cmp_eq_u32 s31, 0
    s_cbranch_scc1 L_st_21
    global_store_short v18, v4, s[34:35]
    s_branch L_st_22
L_st_21:
    global_store_short v18, v4, s[34:35] sc1
L_st_22:
    s_cmp_lg_u32 s48, 0
    s_cbranch_scc1 L_mo_23
    v_mul_f32 v4, v136, v156
    v_fmac_f32 v4, v137, v157
    v_fmac_f32 v4, v138, v158
    v_fmac_f32 v4, v139, v159
    s_nop 1
    v_add_f32_dpp v4, v4, v4 quad_perm:[1,0,3,2] row_mask:0xf bank_mask:0xf
    s_nop 1
    v_add_f32_dpp v4, v4, v4 quad_perm:[2,3,0,1] row_mask:0xf bank_mask:0xf
    s_nop 1
    v_add_f32_dpp v4, v4, v4 row_half_mirror row_mask:0xf bank_mask:0xf
    s_nop 1
    v_add_f32_dpp v4, v4, v4 row_mirror row_mask:0xf bank_mask:0xf
    s_mov_b32 exec_lo, 0x00020002
    s_mov_b32 exec_hi, 0x00020002
    s_cmp_eq_u32 s31, 0
    s_cbranch_scc1 L_st_24
    global_store_dword v9, v4, s[34:35]
    s_branch L_st_25
L_st_24:
    global_store_dword v9, v4, s[34:35] sc1
L_st_25:
    s_mov_b64 exec, -1
L_mo_23:
    s_cmp_lg_u32 s43, 0
    s_cbranch_scc1 L_l0_26
    v_add_u32 v3, 106496, v7
    s_mov_b32 exec_lo, 0
    s_mov_b32 exec_hi, 0xffff
    s_cmp_eq_u32 s31, 0
    s_cbranch_scc1 L_st_27
    global_store_dword v3, v10, s[34:35]
    s_branch L_st_28
L_st_27:
    global_store_dword v3, v10, s[34:35] sc1
L_st_28:
    s_mov_b64 exec, -1
    s_and_b32 s52, s29, 7
    s_lshl_b32 s53, s38, 3
    s_add_u32 s52, s52, s53
    s_mov_b32 s53, 8
    s_mov_b32 s98, 1
    s_mov_b64 exec, 0
    s_branch L_TENT
L_TRET1:
    s_mov_b64 exec, -1
    v_mov_b32 v28, 4944
    s_mov_b32 s65, 0x100000
L_lw_29:
    s_sub_u32 s65, s65, 1
    s_cbranch_scc1 L_lwd_30
    s_sleep 1
    ds_read_b32 v29, v28
    s_waitcnt lgkmcnt(0)
    v_readfirstlane_b32 s52, v29
    s_nop 0
    s_cmp_lg_u32 s52, 1
    s_cbranch_scc1 L_lw_29
L_lwd_30:
    ds_read_b64_tr_b16 v[48:49], v19 offset:40960
    ds_read_b64_tr_b16 v[50:51], v19 offset:41472
    ds_read_b64_tr_b16 v[52:53], v19 offset:45056
    ds_read_b64_tr_b16 v[54:55], v19 offset:45568
    ds_read_b64_tr_b16 v[56:57], v19 offset:49152
    ds_read_b64_tr_b16 v[58:59], v19 offset:49664
    ds_read_b64_tr_b16 v[60:61], v19 offset:53248
    ds_read_b64_tr_b16 v[62:63], v19 offset:53760
    s_waitcnt lgkmcnt(0)
    s_branch L_b4_31
L_l0_26:
    s_barrier
L_b4_31:
    s_barrier
    s_cmp_lt_u32 s28, 4
    s_cselect_b32 s52, 8, 6
    s_cmp_ge_u32 s32, s52
    s_cbranch_scc1 L_nog_32
    s_cmp_lg_u32 s43, 0
    s_cbranch_scc1 L_g1_33
    v_cmp_lt_u32 vcc, 31, v0
    v_mov_b32 v3, 73728
    s_nop 0
    v_cndmask_b32 v3, 0, v3, vcc
    v_add3_u32 v3, v3, v7, s59
    v_add_u32 v4, 512, v14
    v_add_u32 v28, 1024, v14
    v_cmp_lt_u32 vcc, 7, v1
    s_nop 1
    v_cndmask_b32 v4, v4, v28, vcc
    ds_read_b128 v[124:127], v4 offset:0
    ds_read_b128 v[128:131], v4 offset:64
    ds_read_b128 v[132:135], v4 offset:128
    ds_read_b128 v[136:139], v4 offset:192
    s_waitcnt lgkmcnt(3)
    v_mfma_f32_16x16x32_bf16 v[120:123], v[124:127], v[48:51], 0
    s_waitcnt lgkmcnt(2)
    v_mfma_f32_16x16x32_bf16 v[120:123], v[128:131], v[52:55], v[120:123]
    s_waitcnt lgkmcnt(1)
    v_mfma_f32_16x16x32_bf16 v[120:123], v[132:135], v[56:59], v[120:123]
    s_waitcnt lgkmcnt(0)
    v_mfma_f32_16x16x32_bf16 v[120:123], v[136:139], v[60:63], v[120:123]
    s_mov_b32 exec_lo, 0xffff
    s_mov_b32 exec_hi, 0xffff
    s_cmp_eq_u32 s31, 0
    s_cbranch_scc1 L_st_35
    s_nop 3
    global_store_dword v3, v120, s[34:35]
    s_branch L_st_36
L_st_35:
    global_store_dword v3, v120, s[34:35] sc1
L_st_36:
    s_mov_b64 exec, -1
    s_branch L_g2_34
L_g1_33:
L_TP5:
    s_cbranch_execz L_TX5
    ds_read_b128 v[124:127], v14 offset:512
    ds_read_b128 v[128:131], v14 offset:576
    ds_read_b128 v[132:135], v14 offset:640
    ds_read_b128 v[136:139], v14 offset:704
L_TP6:
    s_cbranch_execz L_TX6
    v_add_u32 v3, s59, v7
    s_waitcnt lgkmcnt(3)
    v_mfma_f32_16x16x32_bf16 v[120:123], v[124:127], v[48:51], 0
    s_waitcnt lgkmcnt(2)
    v_mfma_f32_16x16x32_bf16 v[120:123], v[128:131], v[52:55], v[120:123]
    s_waitcnt lgkmcnt(1)
    v_mfma_f32_16x16x32_bf16 v[120:123], v[132:135], v[56:59], v[120:123]
    s_waitcnt lgkmcnt(0)
    v_mfma_f32_16x16x32_bf16 v[120:123], v[136:139], v[60:63], v[120:123]
    s_mov_b64 exec, 0xffff
L_TP7:
    s_cbranch_execz L_TX7
    s_cmp_eq_u32 s31, 0
    s_cbranch_scc1 L_st_37
    s_nop 4
    global_store_dword v3, v120, s[34:35]
    s_branch L_st_38
L_st_37:
    global_store_dword v3, v120, s[34:35] sc1
L_st_38:
    s_mov_b64 exec, -1
L_g2_34:
L_nog_32:
    s_cmp_lg_u32 s43, 0
    s_cbranch_scc1 L_l0_39
    v_mov_b32 v28, 4948
    s_mov_b32 s65, 0x100000
L_lw_40:
    s_sub_u32 s65, s65, 1
    s_cbranch_scc1 L_lwd_41
    s_sleep 1
    ds_read_b32 v29, v28
    s_waitcnt lgkmcnt(0)
    v_readfirstlane_b32 s52, v29
    s_nop 0
    s_cmp_lg_u32 s52, 1
    s_cbranch_scc1 L_lw_40
L_lwd_41:
    ds_read_b64_tr_b16 v[64:65], v19 offset:57344
    ds_read_b64_tr_b16 v[66:67], v19 offset:57856
    ds_read_b64_tr_b16 v[68:69], v19 offset:61440
    ds_read_b64_tr_b16 v[70:71], v19 offset:61952
    s_waitcnt lgkmcnt(0)
L_l0_39:
    s_barrier
    ds_read_b128 v[124:127], v14 offset:768
    ds_read_b128 v[128:131], v14 offset:832
    s_waitcnt lgkmcnt(1)
    v_mfma_f32_16x16x32_bf16 v[120:123], v[124:127], v[64:67], 0
    s_waitcnt lgkmcnt(0)
    v_mfma_f32_16x16x32_bf16 v[120:123], v[128:131], v[68:71], v[120:123]
    s_mov_b64 exec, 0xffff
    s_nop 6
    v_cvt_pk_bf16_f32 v120, v120, v120
    global_store_short v15, v120, s[40:41] sc1
    s_mov_b64 exec, -1
    s_add_u32 s43, s43, 1
    s_add_u32 s34, s34, 53248
    s_addc_u32 s35, s35, 0
    s_add_u32 s40, s40, 65536
    s_addc_u32 s41, s41, 0
    v_add_u32 v7, 32768, v7
    s_mov_b32 s59, 9216
    s_mov_b32 s48, 1
    s_cmp_lt_u32 s43, 2
    s_cbranch_scc1 L_Mloop
    s_cmp_lg_u32 s29, 5
    s_cbranch_scc1 L_fin
    s_cmp_lg_u32 s38, 0
    s_cbranch_scc1 L_fin
    s_waitcnt vmcnt(0)
    s_sleep 4
    buffer_wbl2 sc1
    s_branch L_fin
    s_nop 0
    s_nop 0
    s_nop 0
    s_nop 0
    s_nop 0
    s_nop 0
    s_nop 0
    s_nop 0
    s_nop 0
    s_nop 0
    s_nop 0
    s_nop 0
    s_nop 0
    s_nop 0
    s_nop 0
    s_nop 0
    s_nop 0
    s_nop 0
    s_nop 0
    s_nop 0
    s_nop 0
    s_nop 0
    s_nop 0
    s_nop 0
    s_nop 0
    s_nop 0
    s_nop 0
    s_nop 0
    s_nop 0
    s_nop 0
    s_nop 0
L_D:
    s_and_b32 s32, s29, 7
    s_lshr_b32 s33, s29, 3
    v_and_b32 v0, 63, v0
    s_and_b32 s38, s30, 3
    v_and_b32 v1, 15, v0
    v_lshrrev_b32 v2, 4, v0
    s_lshl_b32 s54, s33, 20
    s_lshl_b32 s55, s30, 17
    s_add_u32 s54, s54, s55
    s_lshl_b32 s55, s28, 10
    s_add_u32 s54, s54, s55
    s_lshl_b32 s55, s32, 7
    s_add_u32 s54, s54, s55
    v_and_b32 v4, 7, v0
    v_bfe_u32 v28, v0, 4, 1
    v_lshlrev_b32 v28, 1, v28
    v_xor_b32 v4, v4, v28
    v_lshlrev_b32 v4, 4, v4
    v_lshrrev_b32 v3, 3, v0
    v_lshl_add_u32 v28, v3, 13, v4
    v_xor_b32 v29, 64, v28
    v_add_u32 v29, 0x10000, v29
    s_lshl_b32 s53, s30, 11
    s_add_u32 s53, s53, 8192
    s_mov_b32 m0, s53
    s_mul_i32 s56, s28, 124928
    s_add_u32 s56, s56, 196608
    s_mul_i32 s57, s28, 9472
    s_add_u32 s57, s57, 1196032
    v_and_b32 v4, 7, v0
    v_lshl_add_u32 v3, v4, 2, v2
    s_lshl_b32 s52, s38, 5
    v_add_u32 v3, s52, v3
    v_lshlrev_b32 v11, 1, v3
    s_lshl_b32 s52, s33, 8
    v_add_u32 v3, s52, v11
    v_lshlrev_b32 v31, 4, v0
    v_mov_b32 v25, 0
    s_waitcnt lgkmcnt(0)
    s_memrealtime s[62:63]
    s_add_u32 s34, s26, s56
    s_addc_u32 s35, s27, 0
    s_add_u32 s36, s26, s57
    s_addc_u32 s37, s27, 0
    s_add_u32 s40, s26, 65536
    s_addc_u32 s41, s27, 0
    v_mov_b32 v136, -1
    v_mov_b32 v137, -1
    v_mov_b32 v138, -1
    v_mov_b32 v139, -1
    s_lshl_b32 s52, s28, 2
    s_add_u32 s52, s52, 4096
    v_lshl_add_u32 v3, v0, 7, s52
    s_cmp_lg_u32 s29, 0
    s_cbranch_scc1 L_pub_42
    s_waitcnt lgkmcnt(0)
    v_mov_b32 v4, s62
    s_mov_b64 exec, 0xffffffff
    global_store_dword v3, v4, s[26:27] sc1
    s_mov_b64 exec, -1
L_pub_42:
    global_load_dword v25, v25, s[26:27] offset:0 sc1
    s_lshl_b32 s52, s29, 10
    v_add_u32 v3, s52, v31
    global_store_dwordx4 v3, v[136:139], s[34:35] sc1
    s_nop 1
    v_add_u32 v3, 0x8000, v3
L_clx_43:
    global_store_dwordx4 v3, v[136:139], s[34:35] sc1
    s_nop 1
    v_add_u32 v3, 0x8000, v3
L_clx_44:
    global_store_dwordx4 v3, v[136:139], s[34:35] sc1
    s_nop 1
    v_add_u32 v3, 0x8000, v3
L_clx_45:
    s_cmp_ge_u32 s29, 26
    s_cbranch_scc1 L_clx_46
    global_store_dwordx4 v3, v[136:139], s[34:35] sc1
    s_nop 1
    v_add_u32 v3, 0x8000, v3
L_clx_46:
    s_lshl_b32 s52, s2, 9
    s_add_u32 s52, s52, 0
    v_add_u32 v3, s52, v31
    s_mov_b64 exec, 0xffffffff
    s_mov_b32 exec_hi, 0
    global_store_dwordx4 v3, v[136:139], s[40:41] sc1
    s_mov_b64 exec, -1
    s_nop 0
    v_lshlrev_b32 v3, 2, v0
    v_mov_b32 v4, 0x3f803f80
    ds_write_b32 v3, v4 offset:1024
    v_mov_b32 v4, 0
    ds_write_b32 v3, v4 offset:768
    s_mov_b64 exec, 0xffff
    ds_write_b32 v3, v4 offset:4928
    s_mov_b64 exec, -1
    s_getreg_b32 s58, hwreg(HW_REG_XCC_ID)
    s_and_b32 s58, s58, 15
    s_lshl_b32 s58, s58, 8
    s_movk_i32 s42, 0x400
    s_movk_i32 s39, 3584
    s_mov_b32 s43, 0
    s_lshl_b32 s46, s28, 8
    s_movk_i32 s47, 64
    s_cmp_lt_u32 s28, 4
    s_cbranch_scc1 L_fr_47
    s_mul_i32 s46, s28, 192
    s_add_u32 s46, s46, 256
    s_movk_i32 s47, 48
L_fr_47:
    s_waitcnt lgkmcnt(0)
    s_barrier
    s_lshl_b32 s53, s29, 2
    s_add_u32 s53, s53, 9216
    v_mov_b32 v3, s53
    s_waitcnt vmcnt(0)
    v_readfirstlane_b32 s60, v25
    s_nop 0
    s_add_u32 s60, s60, 1
    s_and_b32 s61, s60, 0xff
    s_or_b32 s52, s58, s61
    v_mov_b32 v4, s52
    s_mov_b64 exec, 1
    global_store_dword v3, v4, s[36:37]
    s_mov_b64 exec, -1
    v_mov_b32 v28, 4964
    v_mov_b32 v29, 1
    s_mov_b64 exec, 1
    ds_add_u32 v28, v29
    s_mov_b64 exec, -1
    v_lshlrev_b32 v17, 4, v2
    v_lshlrev_b32 v6, 2, v0
    s_bfe_u32 s52, s29, 0x30001
    s_lshl_b32 s52, s52, 4
    s_lshr_b32 s53, s29, 4
    s_lshl_b32 s53, s53, 3
    s_add_u32 s52, s52, s53
    s_and_b32 s53, s29, 1
    s_lshl_b32 s53, s53, 2
    s_add_u32 s52, s52, s53
    s_add_u32 s52, s52, 104448
    v_lshlrev_b32 v3, 7, v2
    v_lshl_add_u32 v3, v1, 9, v3
    v_add_u32 v9, s52, v3
L_tw_48:
    s_memrealtime s[52:53]
    s_waitcnt lgkmcnt(0)
    s_sub_u32 s52, s52, s62
    s_cmp_ge_i32 s52, 180
    s_cbranch_scc1 L_twd_49
    s_sleep 1
    s_branch L_tw_48
L_twd_49:
    s_mov_b32 s64, 0
    s_lshl_b32 s52, s29, 7
    s_add_u32 s52, s52, 4096
    s_load_dwordx8 s[4:11], s[26:27], s52
    s_waitcnt lgkmcnt(0)
    s_sub_u32 s4, s4, s62
    s_cmp_lt_u32 s4, 300
    s_cselect_b32 s4, s4, 0
    s_max_u32 s64, s64, s4
    s_sub_u32 s5, s5, s62
    s_cmp_lt_u32 s5, 300
    s_cselect_b32 s5, s5, 0
    s_max_u32 s64, s64, s5
    s_sub_u32 s6, s6, s62
    s_cmp_lt_u32 s6, 300
    s_cselect_b32 s6, s6, 0
    s_max_u32 s64, s64, s6
    s_sub_u32 s7, s7, s62
    s_cmp_lt_u32 s7, 300
    s_cselect_b32 s7, s7, 0
    s_max_u32 s64, s64, s7
    s_sub_u32 s8, s8, s62
    s_cmp_lt_u32 s8, 300
    s_cselect_b32 s8, s8, 0
    s_max_u32 s64, s64, s8
    s_sub_u32 s9, s9, s62
    s_cmp_lt_u32 s9, 300
    s_cselect_b32 s9, s9, 0
    s_max_u32 s64, s64, s9
    s_sub_u32 s10, s10, s62
    s_cmp_lt_u32 s10, 300
    s_cselect_b32 s10, s10, 0
    s_max_u32 s64, s64, s10
    s_sub_u32 s11, s11, s62
    s_cmp_lt_u32 s11, 300
    s_cselect_b32 s11, s11, 0
    s_max_u32 s64, s64, s11
    v_mov_b32 v28, 4976
    v_mov_b32 v29, s64
    ds_write_b32 v28, v29
    s_mul_i32 s64, s64, 2
    s_lshr_b32 s64, s64, 2
    s_add_u32 s64, s64, 290
    v_mov_b32 v28, 4936
    s_mov_b32 s65, 0x100000
L_lw_50:
    s_sub_u32 s65, s65, 1
    s_cbranch_scc1 L_lwd_51
    s_sleep 1
    ds_read_b32 v29, v28
    s_waitcnt lgkmcnt(0)
    v_readfirstlane_b32 s52, v29
    s_nop 0
    s_cmp_lg_u32 s52, 4
    s_cbranch_scc1 L_lw_50
L_lwd_51:
L_tw_52:
    s_memrealtime s[52:53]
    s_waitcnt lgkmcnt(0)
    s_sub_u32 s52, s52, s62
    s_cmp_ge_i32 s52, s64
    s_cbranch_scc1 L_twd_53
    s_sleep 1
    s_branch L_tw_52
L_twd_53:
    s_lshl_b32 s52, s28, 19
    s_lshl_b32 s53, s33, 17
    s_add_u32 s52, s52, s53
    s_lshl_b32 s53, s32, 7
    s_add_u32 s52, s52, s53
    s_add_u32 s54, s12, s52
    s_addc_u32 s55, s13, 0
    s_mul_i32 s52, 0, 128
    v_lshrrev_b32 v3, 3, v0
    v_add_u32 v3, s52, v3
    v_and_b32 v4, 7, v0
    v_bfe_u32 v28, v0, 4, 1
    v_lshlrev_b32 v28, 1, v28
    v_xor_b32 v4, v4, v28
    v_lshlrev_b32 v4, 4, v4
    s_lshl_b32 s53, 0, 14
    s_add_u32 s53, s53, 24576
    v_add_u32 v28, 0, v3
    v_mad_u32_u24 v28, v28, s42, v4
    s_add_u32 m0, s53, 0
    s_nop 0
    global_load_lds_dwordx4 v28, s[54:55] nt
    v_add_u32 v28, 8, v3
    v_mad_u32_u24 v28, v28, s42, v4
    v_xor_b32 v28, 64, v28
    s_add_u32 m0, s53, 1024
    s_nop 0
    global_load_lds_dwordx4 v28, s[54:55] nt
    v_add_u32 v28, 16, v3
    v_mad_u32_u24 v28, v28, s42, v4
    s_add_u32 m0, s53, 2048
    s_nop 0
    global_load_lds_dwordx4 v28, s[54:55] nt
    v_add_u32 v28, 24, v3
    v_mad_u32_u24 v28, v28, s42, v4
    v_xor_b32 v28, 64, v28
    s_add_u32 m0, s53, 3072
    s_nop 0
    global_load_lds_dwordx4 v28, s[54:55] nt
    v_add_u32 v28, 32, v3
    v_mad_u32_u24 v28, v28, s42, v4
    s_add_u32 m0, s53, 4096
    s_nop 0
    global_load_lds_dwordx4 v28, s[54:55] nt
    v_add_u32 v28, 40, v3
    v_mad_u32_u24 v28, v28, s42, v4
    v_xor_b32 v28, 64, v28
    s_add_u32 m0, s53, 5120
    s_nop 0
    global_load_lds_dwordx4 v28, s[54:55] nt
    v_add_u32 v28, 48, v3
    v_mad_u32_u24 v28, v28, s42, v4
    s_add_u32 m0, s53, 6144
    s_nop 0
    global_load_lds_dwordx4 v28, s[54:55] nt
    v_add_u32 v28, 56, v3
    v_mad_u32_u24 v28, v28, s42, v4
    v_xor_b32 v28, 64, v28
    s_add_u32 m0, s53, 7168
    s_nop 0
    global_load_lds_dwordx4 v28, s[54:55] nt
    v_add_u32 v28, 64, v3
    v_mad_u32_u24 v28, v28, s42, v4
    s_add_u32 m0, s53, 8192
    s_nop 0
    global_load_lds_dwordx4 v28, s[54:55] nt
    v_add_u32 v28, 72, v3
    v_mad_u32_u24 v28, v28, s42, v4
    v_xor_b32 v28, 64, v28
    s_add_u32 m0, s53, 9216
    s_nop 0
    global_load_lds_dwordx4 v28, s[54:55] nt
    v_add_u32 v28, 80, v3
    v_mad_u32_u24 v28, v28, s42, v4
    s_add_u32 m0, s53, 10240
    s_nop 0
    global_load_lds_dwordx4 v28, s[54:55] nt
    v_add_u32 v28, 88, v3
    v_mad_u32_u24 v28, v28, s42, v4
    v_xor_b32 v28, 64, v28
    s_add_u32 m0, s53, 11264
    s_nop 0
    global_load_lds_dwordx4 v28, s[54:55] nt
    v_add_u32 v28, 96, v3
    v_mad_u32_u24 v28, v28, s42, v4
    s_add_u32 m0, s53, 12288
    s_nop 0
    global_load_lds_dwordx4 v28, s[54:55] nt
    v_add_u32 v28, 104, v3
    v_mad_u32_u24 v28, v28, s42, v4
    v_xor_b32 v28, 64, v28
    s_add_u32 m0, s53, 13312
    s_nop 0
    global_load_lds_dwordx4 v28, s[54:55] nt
    v_add_u32 v28, 112, v3
    v_mad_u32_u24 v28, v28, s42, v4
    s_add_u32 m0, s53, 14336
    s_nop 0
    global_load_lds_dwordx4 v28, s[54:55] nt
    v_add_u32 v28, 120, v3
    v_mad_u32_u24 v28, v28, s42, v4
    v_xor_b32 v28, 64, v28
    s_add_u32 m0, s53, 15360
    s_nop 0
    global_load_lds_dwordx4 v28, s[54:55] nt
    s_waitcnt vmcnt(15)
    s_mul_i32 s52, s33, s47
    s_add_u32 s52, s52, s46
    s_sub_u32 s58, 1791, s52
    s_lshl_b32 s52, s52, 10
    s_lshl_b32 s53, s32, 7
    s_add_u32 s52, s52, s53
    s_add_u32 s54, s20, s52
    s_addc_u32 s55, s21, 0
    s_mul_i32 s52, 0, 64
    v_lshrrev_b32 v3, 3, v0
    v_add_u32 v3, s52, v3
    v_and_b32 v4, 7, v0
    v_bfe_u32 v28, v0, 4, 1
    v_lshlrev_b32 v28, 1, v28
    v_xor_b32 v4, v4, v28
    v_lshlrev_b32 v4, 4, v4
    s_lshl_b32 s53, 0, 13
    s_add_u32 s53, s53, 57344
    v_add_u32 v28, 0, v3
    v_min_u32 v28, s58, v28
    v_mad_u32_u24 v28, v28, s42, v4
    s_add_u32 m0, s53, 0
    s_nop 0
    global_load_lds_dwordx4 v28, s[54:55] nt
    v_add_u32 v28, 8, v3
    v_min_u32 v28, s58, v28
    v_mad_u32_u24 v28, v28, s42, v4
    v_xor_b32 v28, 64, v28
    s_add_u32 m0, s53, 1024
    s_nop 0
    global_load_lds_dwordx4 v28, s[54:55] nt
    v_add_u32 v28, 16, v3
    v_min_u32 v28, s58, v28
    v_mad_u32_u24 v28, v28, s42, v4
    s_add_u32 m0, s53, 2048
    s_nop 0
    global_load_lds_dwordx4 v28, s[54:55] nt
    v_add_u32 v28, 24, v3
    v_min_u32 v28, s58, v28
    v_mad_u32_u24 v28, v28, s42, v4
    v_xor_b32 v28, 64, v28
    s_add_u32 m0, s53, 3072
    s_nop 0
    global_load_lds_dwordx4 v28, s[54:55] nt
    v_add_u32 v28, 32, v3
    v_min_u32 v28, s58, v28
    v_mad_u32_u24 v28, v28, s42, v4
    s_add_u32 m0, s53, 4096
    s_nop 0
    global_load_lds_dwordx4 v28, s[54:55] nt
    v_add_u32 v28, 40, v3
    v_min_u32 v28, s58, v28
    v_mad_u32_u24 v28, v28, s42, v4
    v_xor_b32 v28, 64, v28
    s_add_u32 m0, s53, 5120
    s_nop 0
    global_load_lds_dwordx4 v28, s[54:55] nt
    v_add_u32 v28, 48, v3
    v_min_u32 v28, s58, v28
    v_mad_u32_u24 v28, v28, s42, v4
    s_add_u32 m0, s53, 6144
    s_nop 0
    global_load_lds_dwordx4 v28, s[54:55] nt
    v_add_u32 v28, 56, v3
    v_min_u32 v28, s58, v28
    v_mad_u32_u24 v28, v28, s42, v4
    v_xor_b32 v28, 64, v28
    s_add_u32 m0, s53, 7168
    s_nop 0
    global_load_lds_dwordx4 v28, s[54:55] nt
    s_waitcnt vmcnt(8)
    v_mov_b32 v28, 4940
    v_mov_b32 v29, 1
    s_mov_b64 exec, 1
    ds_add_u32 v28, v29
    s_mov_b64 exec, -1
    v_mov_b32 v28, 4960
    v_mov_b32 v29, 1
    s_mov_b64 exec, 1
    ds_add_u32 v28, v29
    s_mov_b64 exec, -1
    v_mov_b32 v28, 4972
    s_mov_b32 s65, 0x100000
L_lw_54:
    s_sub_u32 s65, s65, 1
    s_cbranch_scc1 L_lwd_55
    ds_read_b32 v29, v28
    s_waitcnt lgkmcnt(0)
    v_readfirstlane_b32 s52, v29
    s_nop 0
    s_cmp_lg_u32 s52, 4
    s_cbranch_scc1 L_lw_54
L_lwd_55:
    s_lshr_b32 s52, s32, 1
    s_cmp_lt_u32 s28, 4
    s_cselect_b32 s53, 3, 2
    s_min_u32 s52, s52, s53
    s_lshl_b32 s52, s52, 7
    s_lshl_b32 s53, s46, 1
    s_add_u32 s52, s52, s53
    s_mul_i32 s53, s33, 458752
    s_add_u32 s52, s52, s53
    s_bitcmp1_b32 s32, 0
    s_cselect_b32 s54, s18, s16
    s_cselect_b32 s55, s19, s17
    s_add_u32 s54, s54, s52
    s_addc_u32 s55, s55, 0
    s_mul_i32 s52, 0, 128
    v_lshrrev_b32 v3, 3, v0
    v_add_u32 v3, s52, v3
    v_and_b32 v4, 7, v0
    v_bfe_u32 v28, v0, 4, 1
    v_lshlrev_b32 v28, 1, v28
    v_xor_b32 v4, v4, v28
    v_lshlrev_b32 v4, 4, v4
    s_lshl_b32 s53, 0, 14
    s_add_u32 s53, s53, 40960
    v_add_u32 v28, 0, v3
    v_mad_u32_u24 v28, v28, s39, v4
    s_add_u32 m0, s53, 0
    s_nop 0
    global_load_lds_dwordx4 v28, s[54:55] nt
    v_add_u32 v28, 8, v3
    v_mad_u32_u24 v28, v28, s39, v4
    v_xor_b32 v28, 64, v28
    s_add_u32 m0, s53, 1024
    s_nop 0
    global_load_lds_dwordx4 v28, s[54:55] nt
    v_add_u32 v28, 16, v3
    v_mad_u32_u24 v28, v28, s39, v4
    s_add_u32 m0, s53, 2048
    s_nop 0
    global_load_lds_dwordx4 v28, s[54:55] nt
    v_add_u32 v28, 24, v3
    v_mad_u32_u24 v28, v28, s39, v4
    v_xor_b32 v28, 64, v28
    s_add_u32 m0, s53, 3072
    s_nop 0
    global_load_lds_dwordx4 v28, s[54:55] nt
    v_add_u32 v28, 32, v3
    v_mad_u32_u24 v28, v28, s39, v4
    s_add_u32 m0, s53, 4096
    s_nop 0
    global_load_lds_dwordx4 v28, s[54:55] nt
    v_add_u32 v28, 40, v3
    v_mad_u32_u24 v28, v28, s39, v4
    v_xor_b32 v28, 64, v28
    s_add_u32 m0, s53, 5120
    s_nop 0
    global_load_lds_dwordx4 v28, s[54:55] nt
    v_add_u32 v28, 48, v3
    v_mad_u32_u24 v28, v28, s39, v4
    s_add_u32 m0, s53, 6144
    s_nop 0
    global_load_lds_dwordx4 v28, s[54:55] nt
    v_add_u32 v28, 56, v3
    v_mad_u32_u24 v28, v28, s39, v4
    v_xor_b32 v28, 64, v28
    s_add_u32 m0, s53, 7168
    s_nop 0
    global_load_lds_dwordx4 v28, s[54:55] nt
    v_add_u32 v28, 64, v3
    v_mad_u32_u24 v28, v28, s39, v4
    s_add_u32 m0, s53, 8192
    s_nop 0
    global_load_lds_dwordx4 v28, s[54:55] nt
    v_add_u32 v28, 72, v3
    v_mad_u32_u24 v28, v28, s39, v4
    v_xor_b32 v28, 64, v28
    s_add_u32 m0, s53, 9216
    s_nop 0
    global_load_lds_dwordx4 v28, s[54:55] nt
    v_add_u32 v28, 80, v3
    v_mad_u32_u24 v28, v28, s39, v4
    s_add_u32 m0, s53, 10240
    s_nop 0
    global_load_lds_dwordx4 v28, s[54:55] nt
    v_add_u32 v28, 88, v3
    v_mad_u32_u24 v28, v28, s39, v4
    v_xor_b32 v28, 64, v28
    s_add_u32 m0, s53, 11264
    s_nop 0
    global_load_lds_dwordx4 v28, s[54:55] nt
    v_add_u32 v28, 96, v3
    v_mad_u32_u24 v28, v28, s39, v4
    s_add_u32 m0, s53, 12288
    s_nop 0
    global_load_lds_dwordx4 v28, s[54:55] nt
    v_add_u32 v28, 104, v3
    v_mad_u32_u24 v28, v28, s39, v4
    v_xor_b32 v28, 64, v28
    s_add_u32 m0, s53, 13312
    s_nop 0
    global_load_lds_dwordx4 v28, s[54:55] nt
    v_add_u32 v28, 112, v3
    v_mad_u32_u24 v28, v28, s39, v4
    s_add_u32 m0, s53, 14336
    s_nop 0
    global_load_lds_dwordx4 v28, s[54:55] nt
    v_add_u32 v28, 120, v3
    v_mad_u32_u24 v28, v28, s39, v4
    v_xor_b32 v28, 64, v28
    s_add_u32 m0, s53, 15360
    s_nop 0
    global_load_lds_dwordx4 v28, s[54:55] nt
    s_waitcnt vmcnt(0)
    v_mov_b32 v28, 4944
    v_mov_b32 v29, 1
    s_mov_b64 exec, 1
    ds_add_u32 v28, v29
    s_mov_b64 exec, -1
    s_barrier
    s_waitcnt vmcnt(0)
    v_mov_b32 v28, 4948
    v_mov_b32 v29, 1
    s_mov_b64 exec, 1
    ds_add_u32 v28, v29
    s_mov_b64 exec, -1
    s_mov_b32 s43, 2
    v_mov_b32 v3, 4928
    ds_read_b32 v21, v3
    v_cmp_eq_u32 vcc, 0, v1
    s_waitcnt lgkmcnt(0)
    v_readfirstlane_b32 s31, v21
    s_barrier
    s_barrier
    s_barrier
    s_barrier
    ds_read_b128 v[136:139], v17 offset:4608
    ds_read2st64_b32 v[156:157], v6 offset0:14 offset1:15
    ds_read2st64_b32 v[158:159], v6 offset0:16 offset1:17
    s_waitcnt lgkmcnt(2)
    v_max3_f32 v3, v136, v137, v138
    v_max_f32 v3, v3, v139
    v_sub_f32 v136, v136, v3
    v_sub_f32 v137, v137, v3
    v_sub_f32 v138, v138, v3
    v_sub_f32 v139, v139, v3
    v_exp_f32 v136, v136
    v_exp_f32 v137, v137
    v_exp_f32 v138, v138
    v_exp_f32 v139, v139
    s_waitcnt lgkmcnt(0)
    v_mul_f32 v4, v136, v156
    v_fmac_f32 v4, v137, v157
    v_fmac_f32 v4, v138, v158
    v_fmac_f32 v4, v139, v159
    s_nop 1
    v_add_f32_dpp v4, v4, v4 quad_perm:[1,0,3,2] row_mask:0xf bank_mask:0xf
    s_nop 1
    v_add_f32_dpp v4, v4, v4 quad_perm:[2,3,0,1] row_mask:0xf bank_mask:0xf
    s_nop 1
    v_add_f32_dpp v4, v4, v4 row_half_mirror row_mask:0xf bank_mask:0xf
    s_nop 1
    v_add_f32_dpp v4, v4, v4 row_mirror row_mask:0xf bank_mask:0xf
    v_cndmask_b32 v4, v4, v3, vcc
    s_mov_b32 exec_lo, 0x00030003
    s_mov_b32 exec_hi, 0x00030003
    s_cmp_eq_u32 s31, 0
    s_cbranch_scc1 L_st_56
    global_store_dword v9, v4, s[34:35]
    s_branch L_st_57
L_st_56:
    global_store_dword v9, v4, s[34:35] sc1
L_st_57:
    s_mov_b64 exec, -1
    s_branch L_fin
L_G:
    s_and_b32 s32, s29, 7
    s_lshr_b32 s33, s29, 3
    v_and_b32 v0, 63, v0
    s_and_b32 s38, s30, 3
    v_and_b32 v1, 15, v0
    v_lshrrev_b32 v2, 4, v0
    s_lshl_b32 s54, s33, 20
    s_lshl_b32 s55, s30, 17
    s_add_u32 s54, s54, s55
    s_lshl_b32 s55, s28, 10
    s_add_u32 s54, s54, s55
    s_lshl_b32 s55, s32, 7
    s_add_u32 s54, s54, s55
    v_and_b32 v4, 7, v0
    v_bfe_u32 v28, v0, 4, 1
    v_lshlrev_b32 v28, 1, v28
    v_xor_b32 v4, v4, v28
    v_lshlrev_b32 v4, 4, v4
    v_lshrrev_b32 v3, 3, v0
    v_lshl_add_u32 v28, v3, 13, v4
    v_xor_b32 v29, 64, v28
    v_add_u32 v29, 0x10000, v29
    s_lshl_b32 s53, s30, 11
    s_add_u32 s53, s53, 8192
    s_mov_b32 m0, s53
    s_mul_i32 s56, s28, 124928
    s_add_u32 s56, s56, 196608
    s_mul_i32 s57, s28, 9472
    s_add_u32 s57, s57, 1196032
    v_and_b32 v4, 7, v0
    v_lshl_add_u32 v3, v4, 2, v2
    s_lshl_b32 s52, s38, 5
    v_add_u32 v3, s52, v3
    v_lshlrev_b32 v11, 1, v3
    s_lshl_b32 s52, s33, 8
    v_add_u32 v3, s52, v11
    v_lshlrev_b32 v31, 4, v0
    v_mov_b32 v25, 0
    s_waitcnt lgkmcnt(0)
    s_add_u32 s54, s10, s54
    s_addc_u32 s55, s11, 0
    global_load_dword v25, v25, s[26:27] offset:0 sc1
    s_cmp_lg_u32 s38, 0
    s_cbranch_scc1 L_sb_59
    global_load_dwordx4 v[120:123], v31, s[4:5]
L_sb_59:
    global_load_ushort v24, v3, s[4:5]
    global_load_lds_dwordx4 v28, s[54:55] nt
    s_add_u32 m0, s53, 1024
    s_nop 0
    global_load_lds_dwordx4 v29, s[54:55] nt
    s_memrealtime s[62:63]
L_GS:
    s_add_u32 s34, s26, s56
    s_addc_u32 s35, s27, 0
    s_add_u32 s36, s26, s57
    s_addc_u32 s37, s27, 0
    s_add_u32 s40, s26, 65536
    s_addc_u32 s41, s27, 0
    s_mov_b32 s44, 0x3e0293ee
    s_mov_b32 s45, 0xffff0000
    s_mov_b32 s31, 0
    s_mov_b32 s43, 0
    s_movk_i32 s42, 0x400
    s_movk_i32 s39, 3584
    s_lshl_b32 s46, s28, 8
    s_movk_i32 s47, 64
    s_cmp_lt_u32 s28, 4
    s_cbranch_scc1 L_fr_60
    s_mul_i32 s46, s28, 192
    s_add_u32 s46, s46, 256
    s_movk_i32 s47, 48
L_fr_60:
    v_lshrrev_b32 v3, 2, v1
    v_lshlrev_b32 v3, 6, v3
    v_lshl_add_u32 v16, v2, 4, v3
    v_lshlrev_b32 v17, 4, v2
    v_mov_b32 v14, v17
    s_lshr_b32 s52, s30, 1
    s_lshl_b32 s52, s52, 11
    s_lshr_b32 s53, s29, 1
    s_lshl_b32 s53, s53, 7
    s_add_u32 s52, s52, s53
    s_and_b32 s53, s30, 1
    s_lshl_b32 s53, s53, 6
    s_add_u32 s52, s52, s53
    s_and_b32 s53, s29, 1
    s_lshl_b32 s53, s53, 1
    s_add_u32 s52, s52, s53
    v_lshlrev_b32 v3, 13, v2
    v_lshl_add_u32 v3, v1, 2, v3
    v_add_u32 v18, s52, v3
    v_bfe_u32 v3, v0, 2, 2
    v_lshl_add_u32 v4, v2, 3, v3
    v_lshrrev_b32 v3, 1, v3
    v_and_b32 v28, 1, v2
    v_lshl_add_u32 v3, v28, 1, v3
    v_xor_b32 v3, s38, v3
    v_bfe_u32 v28, v0, 1, 1
    v_lshl_add_u32 v3, v3, 1, v28
    v_lshlrev_b32 v3, 4, v3
    v_lshl_add_u32 v3, v4, 7, v3
    v_and_b32 v28, 1, v0
    v_lshl_add_u32 v19, v28, 3, v3
    s_lshl_b32 s52, s32, 12
    s_lshr_b32 s53, s38, 1
    s_lshl_b32 s53, s53, 11
    s_add_u32 s52, s52, s53
    s_lshl_b32 s53, s28, 8
    s_add_u32 s52, s52, s53
    s_lshr_b32 s53, s33, 1
    s_lshl_b32 s53, s53, 7
    s_add_u32 s52, s52, s53
    s_and_b32 s53, s33, 1
    s_lshl_b32 s53, s53, 1
    s_add_u32 s52, s52, s53
    s_and_b32 s53, s38, 1
    s_lshl_b32 s53, s53, 6
    s_add_u32 s52, s52, s53
    v_lshl_add_u32 v15, v1, 2, s52
    s_lshl_b32 s52, s28, 23
    s_lshl_b32 s53, s29, 11
    s_add_u32 s52, s52, s53
    s_lshl_b32 s53, s38, 16
    s_add_u32 s52, s52, s53
    s_add_u32 s52, s52, 7340032
    s_add_u32 s56, s8, s52
    s_addc_u32 s57, s9, 0
    v_bfe_u32 v3, v0, 1, 3
    v_and_b32 v4, 1, v2
    v_xor_b32 v3, v3, v4
    v_lshlrev_b32 v3, 5, v3
    v_lshl_add_u32 v3, v2, 8, v3
    v_and_b32 v4, 1, v0
    v_lshl_add_u32 v140, v4, 4, v3
    v_xor_b32 v141, 128, v140
    v_xor_b32 v142, 0x40, v140
    v_xor_b32 v143, 0xc0, v140
    v_bfe_u32 v3, v0, 3, 1
    v_bfe_u32 v4, v0, 2, 1
    v_lshl_add_u32 v28, v2, 2, v3
    v_lshl_add_u32 v28, v4, 4, v28
    v_lshl_add_u32 v3, v4, 1, v3
    v_and_b32 v4, 1, v2
    v_lshl_add_u32 v3, v4, 2, v3
    v_xor_b32 v3, s30, v3
    v_lshlrev_b32 v3, 5, v3
    v_lshl_add_u32 v3, v28, 8, v3
    v_and_b32 v4, 3, v0
    v_lshl_add_u32 v3, v4, 3, v3
    v_add_u32 v30, 65536, v3
    s_lshl_b32 s52, s33, 13
    s_lshl_b32 s53, s38, 11
    s_add_u32 s52, s52, s53
    v_add_u32 v5, s52, v31
    s_mov_b32 s42, 0x3f803f80
    s_lshl_b32 s52, s33, 7
    s_add_u32 s52, s52, 51200
    v_lshrrev_b32 v3, 3, v0
    v_lshl_add_u32 v6, v3, 4, s52
    v_lshrrev_b32 v3, 5, v0
    v_mul_u32_u24 v3, 2304, v3
    v_and_b32 v4, 31, v0
    v_lshl_add_u32 v3, v4, 4, v3
    s_lshl_b32 s52, s38, 9
    s_add_u32 s52, s52, 2304
    v_add_u32 v7, s52, v3
    s_lshl_b32 s52, s38, 6
    s_add_u32 s52, s52, 52224
    v_and_b32 v3, 3, v0
    v_lshl_add_u32 v8, v3, 3, s52
    s_mul_i32 s52, s38, 272
    s_add_u32 s52, s52, 1280
    v_lshlrev_b32 v3, 3, v4
    v_lshrrev_b32 v4, 5, v0
    v_lshl_add_u32 v3, v4, 2, v3
    v_add_u32 v12, s52, v3
    s_mul_i32 s52, s33, s47
    s_lshl_b32 s53, s38, 4
    s_add_u32 s52, s52, s53
    s_lshr_b32 s53, s52, 6
    s_and_b32 s52, s52, 63
    s_lshl_b32 s54, s53, 9
    s_lshl_b32 s52, s52, 2
    s_add_u32 s52, s52, s54
    s_add_u32 s52, s52, 41984
    v_mul_u32_u24 v3, 2304, v2
    v_lshl_add_u32 v3, v1, 2, v3
    v_add_u32 v9, s52, v3
    s_lshl_b32 s53, s53, 6
    s_add_u32 s53, s53, 52480
    v_and_b32 v3, 3, v0
    v_lshl_add_u32 v10, v3, 3, s53
    s_lshl_b32 s52, s38, 5
    s_add_u32 s52, s52, 768
    v_lshl_add_u32 v13, v1, 1, s52
    s_getreg_b32 s58, hwreg(HW_REG_XCC_ID)
    s_and_b32 s58, s58, 15
    s_lshl_b32 s58, s58, 8
    s_nop 1
    s_waitcnt vmcnt(0) lgkmcnt(0)
    v_lshlrev_b32 v24, 16, v24
    v_readfirstlane_b32 s60, v25
    s_nop 0
    s_add_u32 s60, s60, 1
    s_and_b32 s61, s60, 0xff
    s_cmp_eq_u32 s38, 0
    s_cbranch_scc1 L_Gb1x
    s_branch L_Gb1
    s_nop 0
    s_nop 0
L_Gloop:
L_TP8:
    s_cbranch_execz L_TX8
    v_add_u32 v3, 32768, v7
    global_load_dword v48, v8, s[34:35] offset:0
    global_load_dword v48, v3, s[34:35] offset:-2304
    global_load_dword v48, v6, s[34:35] offset:0
    global_load_dword v48, v5, s[34:35] offset:0
    global_load_dword v48, v5, s[34:35] offset:1024
    global_load_dword v48, v6, s[34:35] offset:512
L_TP9:
    s_cbranch_execz L_TX9
    global_load_dword v48, v10, s[34:35] offset:0
    global_load_dword v48, v9, s[34:35] offset:0
    global_load_dword v48, v9, s[34:35] offset:256
    v_add_u32 v3, 32768, v5
    s_sleep 10
    s_mov_b32 s65, 20000
    global_load_dwordx4 v[120:123], v3, s[48:49] offset:0
    global_load_dwordx4 v[124:127], v3, s[48:49] offset:1024
L_TP10:
    s_cbranch_execz L_TX10
    s_branch L_gh_62
L_gr_61:
    s_sub_u32 s65, s65, 1
    s_cbranch_scc1 L_gd_63
    global_load_dwordx4 v[120:123], v3, s[48:49] offset:0 sc1
    global_load_dwordx4 v[124:127], v3, s[48:49] offset:1024 sc1
L_gh_62:
    s_waitcnt vmcnt(1)
    v_dot2_f32_bf16 v136, v120, s42, 0
    v_dot2_f32_bf16 v137, v121, s42, 0
    v_dot2_f32_bf16 v138, v122, s42, 0
    v_dot2_f32_bf16 v139, v123, s42, 0
L_TP11:
    s_cbranch_execz L_TX11
    s_waitcnt vmcnt(0)
    v_dot2_f32_bf16 v136, v124, s42, v136
    v_dot2_f32_bf16 v137, v125, s42, v137
    v_dot2_f32_bf16 v138, v126, s42, v138
    v_dot2_f32_bf16 v139, v127, s42, v139
    s_nop 1
    v_permlane32_swap_b32 v136, v138
    v_permlane32_swap_b32 v137, v139
    v_pk_add_f32 v[136:137], v[136:137], v[138:139]
L_TP12:
    s_cbranch_execz L_TX12
    s_nop 1
    v_permlane16_swap_b32 v136, v137
    v_add_f32 v136, v136, v137
    s_nop 1
    v_add_f32_dpp v136, v136, v136 row_ror:8 row_mask:0xf bank_mask:0xf
    v_cvt_pk_bf16_f32 v137, v136, v136
    v_lshlrev_b32 v137, 16, v137
    v_add_f32 v137, v137, v24
    v_cvt_pk_bf16_f32 v137, v137, v137
    ds_write_b16 v11, v137 offset:0
    v_cmp_u_f32 vcc, v136, v136
L_TP13:
    s_cbranch_execz L_TX13
    s_cbranch_vccnz L_gr_61
L_gd_63:
    v_lshlrev_b32 v24, 16, v137
    s_waitcnt lgkmcnt(0)
L_Gb1:
    s_barrier
    s_cmp_lg_u32 s43, 0
    s_cbranch_scc1 L_q1_65
L_Gb1x:
    v_and_b32 v3, 31, v0
    v_lshlrev_b32 v3, 2, v3
    v_add_u32 v144, 9216, v3
    s_mov_b32 s64, 195
    v_mov_b32 v28, 4932
    s_mov_b32 s65, 0x100000
L_lw_68:
    s_sub_u32 s65, s65, 1
    s_cbranch_scc1 L_lwd_69
    ds_read_b32 v29, v28
    s_waitcnt lgkmcnt(0)
    v_readfirstlane_b32 s52, v29
    s_nop 0
    s_cmp_lg_u32 s52, 4
    s_cbranch_scc1 L_lw_68
L_lwd_69:
    s_lshl_b32 s52, s38, 13
    s_add_u32 s52, s52, 65536
    s_add_u32 m0, s52, 0
    s_nop 0
    global_load_lds_dwordx4 v140, s[56:57] offset:0 nt
    global_load_lds_dwordx4 v141, s[56:57] offset:1024 nt
L_tq_67:
    s_sleep 1
    s_memrealtime s[52:53]
    s_waitcnt lgkmcnt(0)
    s_sub_u32 s52, s52, s62
    s_cmp_lt_u32 s52, s64
    s_cbranch_scc1 L_tq_67
    s_mov_b32 s65, 0x100000
    s_mov_b32 s64, 6
    s_mov_b32 s59, 0
    global_load_dwordx4 v[120:123], v7, s[36:37] offset:-2304 sc1
    global_load_dwordx4 v[124:127], v7, s[36:37] offset:2304 sc1
    s_cmp_lg_u32 s38, 0
    s_cbranch_scc1 L_sb_74
    global_load_dword v128, v144, s[36:37] sc1
L_sb_74:
    v_mov_b32 v28, 4980
    v_mov_b32 v29, 1
    s_mov_b64 exec, 1
    ds_add_u32 v28, v29
    s_mov_b64 exec, -1
    v_mov_b32 v28, 4980
    s_mov_b32 s65, 0x100000
L_lw_75:
    s_sub_u32 s65, s65, 1
    s_cbranch_scc1 L_lwd_76
    ds_read_b32 v29, v28
    s_waitcnt lgkmcnt(0)
    v_readfirstlane_b32 s52, v29
    s_nop 0
    s_cmp_lg_u32 s52, 4
    s_cbranch_scc1 L_lw_75
L_lwd_76:
    s_mov_b32 s65, 0x100000
    s_lshl_b32 s52, s38, 13
    s_add_u32 s52, s52, 65536
    s_add_u32 s56, s56, 262144
    s_addc_u32 s57, s57, 0
    s_add_u32 m0, s52, 2048
    s_nop 0
    global_load_lds_dwordx4 v140, s[56:57] offset:0 nt
    global_load_lds_dwordx4 v141, s[56:57] offset:1024 nt
    s_add_u32 s56, s56, 262144
    s_addc_u32 s57, s57, 0
    s_add_u32 m0, s52, 4096
    s_nop 0
    global_load_lds_dwordx4 v142, s[56:57] offset:0 nt
    global_load_lds_dwordx4 v143, s[56:57] offset:1024 nt
    s_add_u32 s56, s56, 262144
    s_addc_u32 s57, s57, 0
    s_add_u32 m0, s52, 6144
    s_nop 0
    global_load_lds_dwordx4 v142, s[56:57] offset:0 nt
    global_load_lds_dwordx4 v143, s[56:57] offset:1024 nt
    v_mov_b32 v28, 4936
    v_mov_b32 v29, 1
    s_mov_b64 exec, 1
    ds_add_u32 v28, v29
    s_mov_b64 exec, -1
    s_waitcnt vmcnt(6)
    s_branch L_q0h_71
L_q0p_70:
    s_sub_u32 s65, s65, 1
    s_cbranch_scc1 L_q0d_72
    s_sub_u32 s64, s64, 1
    s_cmp_lg_u32 s64, 0
    s_cbranch_scc1 L_q0n_73
    s_cmp_lg_u32 s38, 0
    s_cbranch_scc1 L_q0n_73
    s_cmp_lg_u32 s59, 0
    s_cbranch_scc1 L_wo1_77
    v_mov_b32 v28, 4932
    s_mov_b32 s65, 0x100000
L_lw_78:
    s_sub_u32 s65, s65, 1
    s_cbranch_scc1 L_lwd_79
    ds_read_b32 v29, v28
    s_waitcnt lgkmcnt(0)
    v_readfirstlane_b32 s52, v29
    s_nop 0
    s_cmp_lg_u32 s52, 4
    s_cbranch_scc1 L_lw_78
L_lwd_79:
    v_mov_b32 v28, 4964
    s_mov_b32 s65, 0x100000
L_lw_80:
    s_sub_u32 s65, s65, 1
    s_cbranch_scc1 L_lwd_81
    ds_read_b32 v29, v28
    s_waitcnt lgkmcnt(0)
    v_readfirstlane_b32 s52, v29
    s_nop 0
    s_cmp_lg_u32 s52, 1
    s_cbranch_scc1 L_lw_80
L_lwd_81:
    v_lshlrev_b32 v3, 2, v0
    ds_read_b32 v4, v3 offset:4672
    s_mul_i32 s52, s33, 2304
    s_lshl_b32 s53, s32, 8
    s_add_u32 s52, s52, s53
    v_add_u32 v3, s52, v3
    s_waitcnt lgkmcnt(0)
    global_store_dword v3, v4, s[36:37] sc1
    s_or_b32 s52, s58, s61
    s_lshl_b32 s53, s29, 2
    s_add_u32 s53, s53, 9216
    v_mov_b32 v3, s53
    v_mov_b32 v4, s52
    s_mov_b64 exec, 1
    global_store_dword v3, v4, s[36:37] sc1
    s_mov_b64 exec, -1
    s_mov_b32 s59, 1
L_wo1_77:
L_q0n_73:
    global_load_dwordx4 v[120:123], v7, s[36:37] offset:-2304 sc1
    global_load_dwordx4 v[124:127], v7, s[36:37] offset:2304 sc1
    s_cmp_lg_u32 s38, 0
    s_cbranch_scc1 L_sb_82
    global_load_dword v128, v144, s[36:37] sc1
L_sb_82:
    s_waitcnt vmcnt(0)
L_q0h_71:
    s_cmp_lg_u32 s38, 0
    s_cbranch_scc1 L_sb_83
    v_xor_b32 v128, s61, v128
    v_and_b32 v129, 0xff, v128
    v_cmp_eq_u32 vcc, 0, v129
    v_cmp_ne_u32 s[52:53], s58, v128
    s_nop 0
    s_and_b64 vcc, vcc, s[52:53]
    s_cbranch_scc0 L_rc_84
    s_cmp_lg_u32 s59, 0
    s_cbranch_scc1 L_wo1_85
    v_mov_b32 v28, 4932
    s_mov_b32 s65, 0x100000
L_lw_86:
    s_sub_u32 s65, s65, 1
    s_cbranch_scc1 L_lwd_87
    ds_read_b32 v29, v28
    s_waitcnt lgkmcnt(0)
    v_readfirstlane_b32 s52, v29
    s_nop 0
    s_cmp_lg_u32 s52, 4
    s_cbranch_scc1 L_lw_86
L_lwd_87:
    v_mov_b32 v28, 4964
    s_mov_b32 s65, 0x100000
L_lw_88:
    s_sub_u32 s65, s65, 1
    s_cbranch_scc1 L_lwd_89
    ds_read_b32 v29, v28
    s_waitcnt lgkmcnt(0)
    v_readfirstlane_b32 s52, v29
    s_nop 0
    s_cmp_lg_u32 s52, 1
    s_cbranch_scc1 L_lw_88
L_lwd_89:
    v_lshlrev_b32 v3, 2, v0
    ds_read_b32 v4, v3 offset:4672
    s_mul_i32 s52, s33, 2304
    s_lshl_b32 s53, s32, 8
    s_add_u32 s52, s52, s53
    v_add_u32 v3, s52, v3
    s_waitcnt lgkmcnt(0)
    global_store_dword v3, v4, s[36:37] sc1
    s_or_b32 s52, s58, s61
    s_lshl_b32 s53, s29, 2
    s_add_u32 s53, s53, 9216
    v_mov_b32 v3, s53
    v_mov_b32 v4, s52
    s_mov_b64 exec, 1
    global_store_dword v3, v4, s[36:37] sc1
    s_mov_b64 exec, -1
    s_mov_b32 s59, 1
L_wo1_85:
L_rc_84:
L_sb_83:
    v_xor_b32 v120, s61, v120
    v_xor_b32 v121, s61, v121
    v_xor_b32 v122, s61, v122
    v_xor_b32 v123, s61, v123
    v_xor_b32 v124, s61, v124
    v_xor_b32 v125, s61, v125
    v_xor_b32 v126, s61, v126
    v_xor_b32 v127, s61, v127
    v_or3_b32 v3, v120, v121, v122
    v_or3_b32 v4, v123, v124, v125
    v_or3_b32 v3, v3, v126, v127
    v_or_b32 v3, v3, v4
    v_and_b32 v3, 0xff, v3
    v_cmp_ne_u32 vcc, 0, v3
    s_cbranch_vccnz L_q0p_70
L_q0d_72:
    v_pk_add_f32 v[120:121], v[120:121], v[124:125]
    v_pk_add_f32 v[122:123], v[122:123], v[126:127]
    s_nop 1
    v_permlane32_swap_b32 v120, v122
    v_permlane32_swap_b32 v121, v123
    v_pk_add_f32 v[120:121], v[120:121], v[122:123]
    v_cvt_pk_bf16_f32 v120, v120, v121
    ds_write_b32 v12, v120
    s_branch L_q2_66
L_q1_65:
L_TP14:
    s_cbranch_execz L_TX14
    s_cmp_lg_u32 s38, 0
    s_cbranch_scc1 L_sb_90
    v_lshlrev_b32 v3, 2, v0
    ds_read_b32 v120, v3 offset:0
    s_lshl_b32 s52, s32, 5
    s_lshl_b32 s53, s33, 3
    s_add_u32 s52, s52, s53
    s_add_u32 s52, s52, 52224
L_TP15:
    s_cbranch_execz L_TX15
    v_lshrrev_b32 v3, 5, v0
    v_lshl_add_u32 v3, v3, 2, s52
    s_mov_b32 s52, 0x3f803f80
    s_waitcnt lgkmcnt(0)
    v_dot2_f32_bf16 v121, v120, s52, 0
    v_dot2_f32_bf16 v122, v120, v120, 0
    s_nop 2
    v_permlane32_swap_b32 v121, v122
    v_add_f32 v121, v121, v122
    v_mov_b32 v122, v121
L_TP16:
    s_cbranch_execz L_TX16
    s_nop 1
    v_permlane16_swap_b32 v121, v122
    v_add_f32 v121, v121, v122
    s_nop 1
    v_add_f32_dpp v121, v121, v121 quad_perm:[1,0,3,2] row_mask:0xf bank_mask:0xf
    s_nop 1
    v_add_f32_dpp v121, v121, v121 quad_perm:[2,3,0,1] row_mask:0xf bank_mask:0xf
    s_nop 1
    v_add_f32_dpp v121, v121, v121 row_half_mirror row_mask:0xf bank_mask:0xf
    s_nop 1
    v_add_f32_dpp v121, v121, v121 row_mirror row_mask:0xf bank_mask:0xf
L_TP17:
    s_cbranch_execz L_TX17
    s_mov_b32 exec_lo, 1
    s_mov_b32 exec_hi, 1
    s_cmp_eq_u32 s31, 0
    s_cbranch_scc1 L_st_91
    global_store_dword v3, v121, s[34:35]
    s_branch L_st_92
L_st_91:
    global_store_dword v3, v121, s[34:35] sc1
L_st_92:
    s_mov_b64 exec, -1
L_sb_90:
    v_add_u32 v3, 32768, v7
    s_sleep 6
    s_mov_b32 s65, 20000
L_TP18:
    s_cbranch_execz L_TX18
    global_load_dwordx2 v[128:129], v8, s[34:35] sc1
    global_load_dwordx4 v[124:127], v3, s[34:35] offset:-2304 sc1
    s_branch L_gh_94
L_gr_93:
    s_sub_u32 s65, s65, 1
    s_cbranch_scc1 L_gd_95
    global_load_dwordx2 v[128:129], v8, s[34:35] sc1
    global_load_dwordx4 v[124:127], v3, s[34:35] offset:-2304 sc1
L_gh_94:
    s_waitcnt vmcnt(1)
    v_add_f32_dpp v128, v128, v128 quad_perm:[1,0,3,2] row_mask:0xf bank_mask:0xf
    v_add_f32_dpp v129, v129, v129 quad_perm:[1,0,3,2] row_mask:0xf bank_mask:0xf
L_TP19:
    s_cbranch_execz L_TX19
    s_nop 0
    v_add_f32_dpp v128, v128, v128 quad_perm:[2,3,0,1] row_mask:0xf bank_mask:0xf
    v_add_f32_dpp v129, v129, v129 quad_perm:[2,3,0,1] row_mask:0xf bank_mask:0xf
    v_mul_f32 v130, 0x3b000000, v128
    v_cvt_pk_bf16_f32 v130, v130, v130
    v_lshlrev_b32 v130, 16, v130
    s_waitcnt vmcnt(0)
    v_dot2_f32_bf16 v120, v124, s42, 0
    v_dot2_f32_bf16 v121, v125, s42, 0
L_TP20:
    s_cbranch_execz L_TX20
    v_dot2_f32_bf16 v122, v126, s42, 0
    v_dot2_f32_bf16 v123, v127, s42, 0
    s_nop 1
    v_permlane32_swap_b32 v120, v122
    v_permlane32_swap_b32 v121, v123
    v_pk_add_f32 v[120:121], v[120:121], v[122:123]
    v_pk_fma_f32 v[120:121], v[22:23], v[130:131], v[120:121] op_sel_hi:[1,0,1] neg_lo:[1,0,0] neg_hi:[1,0,0]
    v_cvt_pk_bf16_f32 v122, v120, v121
    ds_write_b32 v12, v122
L_TP21:
    s_cbranch_execz L_TX21
    v_mov_b32 v4, 2368
    ds_write_b64 v4, v[128:129]
    v_fma_f32 v120, v129, 0, v120
    v_cmp_u_f32 vcc, v120, v121
    s_cbranch_vccnz L_gr_93
L_gd_95:
L_q2_66:
    s_cmp_lg_u32 s43, 0
    s_cbranch_scc1 L_sy_97
    v_mov_b32 v28, 4952
    v_mov_b32 v29, 1
    s_mov_b64 exec, 1
    ds_add_u32 v28, v29
    s_mov_b64 exec, -1
    s_branch L_sy_98
L_sy_97:
    s_waitcnt lgkmcnt(0)
    s_barrier
L_sy_98:
    s_cmp_lg_u32 s43, 0
    s_cbranch_scc1 L_l0_99
    s_cmp_lg_u32 s38, 0
    s_cbranch_scc1 L_v1_100
    s_mov_b32 s65, 0x100000
    s_mov_b32 s64, 6
L_rl_102:
    v_and_b32 v129, 0xff, v128
    v_cmp_ne_u32 vcc, 0, v129
    s_cbranch_vccz L_rd_103
    s_sub_u32 s65, s65, 1
    s_cbranch_scc1 L_rd_103
    s_sub_u32 s64, s64, 1
    s_cmp_lg_u32 s64, 0
    s_cbranch_scc1 L_rn_104
    s_cmp_lg_u32 s59, 0
    s_cbranch_scc1 L_wo1_105
    v_mov_b32 v28, 4932
    s_mov_b32 s65, 0x100000
L_lw_106:
    s_sub_u32 s65, s65, 1
    s_cbranch_scc1 L_lwd_107
    ds_read_b32 v29, v28
    s_waitcnt lgkmcnt(0)
    v_readfirstlane_b32 s52, v29
    s_nop 0
    s_cmp_lg_u32 s52, 4
    s_cbranch_scc1 L_lw_106
L_lwd_107:
    v_mov_b32 v28, 4964
    s_mov_b32 s65, 0x100000
L_lw_108:
    s_sub_u32 s65, s65, 1
    s_cbranch_scc1 L_lwd_109
    ds_read_b32 v29, v28
    s_waitcnt lgkmcnt(0)
    v_readfirstlane_b32 s52, v29
    s_nop 0
    s_cmp_lg_u32 s52, 1
    s_cbranch_scc1 L_lw_108
L_lwd_109:
    v_lshlrev_b32 v3, 2, v0
    ds_read_b32 v4, v3 offset:4672
    s_mul_i32 s52, s33, 2304
    s_lshl_b32 s53, s32, 8
    s_add_u32 s52, s52, s53
    v_add_u32 v3, s52, v3
    s_waitcnt lgkmcnt(0)
    global_store_dword v3, v4, s[36:37] sc1
    s_or_b32 s52, s58, s61
    s_lshl_b32 s53, s29, 2
    s_add_u32 s53, s53, 9216
    v_mov_b32 v3, s53
    v_mov_b32 v4, s52
    s_mov_b64 exec, 1
    global_store_dword v3, v4, s[36:37] sc1
    s_mov_b64 exec, -1
    s_mov_b32 s59, 1
L_wo1_105:
L_rn_104:
    global_load_dword v128, v144, s[36:37] sc1
    s_waitcnt vmcnt(0)
    v_xor_b32 v128, s61, v128
    v_and_b32 v129, 0xff, v128
    v_cmp_eq_u32 vcc, 0, v129
    v_cmp_ne_u32 s[52:53], s58, v128
    s_nop 0
    s_and_b64 vcc, vcc, s[52:53]
    s_cbranch_scc0 L_rc_110
    s_cmp_lg_u32 s59, 0
    s_cbranch_scc1 L_wo1_111
    v_mov_b32 v28, 4932
    s_mov_b32 s65, 0x100000
L_lw_112:
    s_sub_u32 s65, s65, 1
    s_cbranch_scc1 L_lwd_113
    ds_read_b32 v29, v28
    s_waitcnt lgkmcnt(0)
    v_readfirstlane_b32 s52, v29
    s_nop 0
    s_cmp_lg_u32 s52, 4
    s_cbranch_scc1 L_lw_112
L_lwd_113:
    v_mov_b32 v28, 4964
    s_mov_b32 s65, 0x100000
L_lw_114:
    s_sub_u32 s65, s65, 1
    s_cbranch_scc1 L_lwd_115
    ds_read_b32 v29, v28
    s_waitcnt lgkmcnt(0)
    v_readfirstlane_b32 s52, v29
    s_nop 0
    s_cmp_lg_u32 s52, 1
    s_cbranch_scc1 L_lw_114
L_lwd_115:
    v_lshlrev_b32 v3, 2, v0
    ds_read_b32 v4, v3 offset:4672
    s_mul_i32 s52, s33, 2304
    s_lshl_b32 s53, s32, 8
    s_add_u32 s52, s52, s53
    v_add_u32 v3, s52, v3
    s_waitcnt lgkmcnt(0)
    global_store_dword v3, v4, s[36:37] sc1
    s_or_b32 s52, s58, s61
    s_lshl_b32 s53, s29, 2
    s_add_u32 s53, s53, 9216
    v_mov_b32 v3, s53
    v_mov_b32 v4, s52
    s_mov_b64 exec, 1
    global_store_dword v3, v4, s[36:37] sc1
    s_mov_b64 exec, -1
    s_mov_b32 s59, 1
L_wo1_111:
L_rc_110:
    s_branch L_rl_102
L_rd_103:
    v_cmp_ne_u32 vcc, s58, v128
    s_nop 0
    s_cmp_eq_u64 vcc, 0
    s_cselect_b32 s31, 1, 0
    v_mov_b32 v3, 4928
    v_mov_b32 v4, s31
    ds_write_b32 v3, v4
    s_cmp_eq_u32 s31, 1
    s_cbranch_scc1 L_rm_116
    s_cmp_lg_u32 s59, 0
    s_cbranch_scc1 L_wo1_117
    v_mov_b32 v28, 4932
    s_mov_b32 s65, 0x100000
L_lw_118:
    s_sub_u32 s65, s65, 1
    s_cbranch_scc1 L_lwd_119
    ds_read_b32 v29, v28
    s_waitcnt lgkmcnt(0)
    v_readfirstlane_b32 s52, v29
    s_nop 0
    s_cmp_lg_u32 s52, 4
    s_cbranch_scc1 L_lw_118
L_lwd_119:
    v_mov_b32 v28, 4964
    s_mov_b32 s65, 0x100000
L_lw_120:
    s_sub_u32 s65, s65, 1
    s_cbranch_scc1 L_lwd_121
    ds_read_b32 v29, v28
    s_waitcnt lgkmcnt(0)
    v_readfirstlane_b32 s52, v29
    s_nop 0
    s_cmp_lg_u32 s52, 1
    s_cbranch_scc1 L_lw_120
L_lwd_121:
    v_lshlrev_b32 v3, 2, v0
    ds_read_b32 v4, v3 offset:4672
    s_mul_i32 s52, s33, 2304
    s_lshl_b32 s53, s32, 8
    s_add_u32 s52, s52, s53
    v_add_u32 v3, s52, v3
    s_waitcnt lgkmcnt(0)
    global_store_dword v3, v4, s[36:37] sc1
    s_or_b32 s52, s58, s61
    s_lshl_b32 s53, s29, 2
    s_add_u32 s53, s53, 9216
    v_mov_b32 v3, s53
    v_mov_b32 v4, s52
    s_mov_b64 exec, 1
    global_store_dword v3, v4, s[36:37] sc1
    s_mov_b64 exec, -1
    s_mov_b32 s59, 1
L_wo1_117:
L_rm_116:
    s_cmp_lg_u32 s29, 0
    s_cbranch_scc1 L_v1_100
    s_lshl_b32 s52, s28, 2
    s_add_u32 s52, s52, 32
    s_mov_b64 exec, 1
    v_mov_b32 v3, s52
    v_mov_b32 v4, 1
    global_store_dword v3, v4, s[24:25] sc1
    s_mov_b64 exec, -1
    s_waitcnt vmcnt(1)
    s_branch L_v2_101
L_v1_100:
    s_waitcnt vmcnt(0)
L_v2_101:
    v_mov_b32 v28, 4956
    v_mov_b32 v29, 1
    s_mov_b64 exec, 1
    ds_add_u32 v28, v29
    s_mov_b64 exec, -1
L_l0_99:
    s_cmp_lg_u32 s43, 0
    s_cbranch_scc1 L_sy_122
    v_mov_b32 v28, 4956
    s_mov_b32 s65, 0x100000
L_lw_124:
    s_sub_u32 s65, s65, 1
    s_cbranch_scc1 L_lwd_125
    ds_read_b32 v29, v28
    s_waitcnt lgkmcnt(0)
    v_readfirstlane_b32 s52, v29
    s_nop 0
    s_cmp_lg_u32 s52, 8
    s_cbranch_scc1 L_lw_124
L_lwd_125:
    s_branch L_sy_123
L_sy_122:
    s_waitcnt lgkmcnt(0)
    s_barrier
L_sy_123:
    s_cmp_lg_u32 s43, 0
    s_cbranch_scc1 L_l0_126
    v_mov_b32 v3, 4928
    ds_read_b32 v21, v3
    ds_read_b64_tr_b16 v[104:105], v30 offset:0
    ds_read_b64_tr_b16 v[106:107], v30 offset:512
    ds_read_b64_tr_b16 v[108:109], v30 offset:8192
    ds_read_b64_tr_b16 v[110:111], v30 offset:8704
    ds_read_b64_tr_b16 v[112:113], v30 offset:16384
    ds_read_b64_tr_b16 v[114:115], v30 offset:16896
    ds_read_b64_tr_b16 v[116:117], v30 offset:24576
    ds_read_b64_tr_b16 v[118:119], v30 offset:25088
L_l0_126:
    ds_read_b128 v[120:123], v16 offset:2560
    ds_read_b128 v[124:127], v16 offset:2816
    ds_read_b128 v[128:131], v16 offset:3072
    ds_read_b128 v[132:135], v16 offset:3328
    ds_read_b128 v[136:139], v17 offset:4608
    s_waitcnt lgkmcnt(0)
    v_readfirstlane_b32 s31, v21
    v_mfma_f32_16x16x32_bf16 v[140:143], v[120:123], v[104:107], 0
    v_mfma_f32_16x16x32_bf16 v[144:147], v[124:127], v[108:111], 0
    v_mfma_f32_16x16x32_bf16 v[148:151], v[128:131], v[112:115], 0
    v_mfma_f32_16x16x32_bf16 v[152:155], v[132:135], v[116:119], 0
    v_max3_f32 v3, v136, v137, v138
    v_max_f32 v3, v3, v139
    v_sub_f32 v136, v136, v3
    v_sub_f32 v137, v137, v3
    v_sub_f32 v138, v138, v3
    v_sub_f32 v139, v139, v3
    v_exp_f32 v136, v136
    v_exp_f32 v137, v137
    v_exp_f32 v138, v138
    v_exp_f32 v139, v139
    v_mul_f32 v4, v136, v140
    v_fmac_f32 v4, v137, v144
    v_fmac_f32 v4, v138, v148
    v_fmac_f32 v4, v139, v152
    v_cvt_pk_bf16_f32 v4, v4, v4
    s_cmp_eq_u32 s31, 0
    s_cbranch_scc1 L_st_127
    global_store_short v18, v4, s[34:35]
    s_branch L_st_128
L_st_127:
    global_store_short v18, v4, s[34:35] sc1
L_st_128:
    s_mov_b32 s59, 1
    s_cmp_lg_u32 s43, 0
    s_cbranch_scc1 L_l0_129
    v_mov_b32 v3, 4940
    ds_read_b32 v4, v3
    s_waitcnt lgkmcnt(0)
    v_readfirstlane_b32 s52, v4
    s_mov_b32 s59, 0
    s_cmp_lg_u32 s52, 1
    s_cbranch_scc1 L_l0_129
    ds_read_b64_tr_b16 v[32:33], v19 offset:24576
    ds_read_b64_tr_b16 v[34:35], v19 offset:25088
    ds_read_b64_tr_b16 v[36:37], v19 offset:28672
    ds_read_b64_tr_b16 v[38:39], v19 offset:29184
    ds_read_b64_tr_b16 v[40:41], v19 offset:32768
    ds_read_b64_tr_b16 v[42:43], v19 offset:33280
    ds_read_b64_tr_b16 v[44:45], v19 offset:36864
    ds_read_b64_tr_b16 v[46:47], v19 offset:37376
    s_mov_b32 s59, 1
L_l0_129:
    s_cmp_lg_u32 s43, 0
    s_cbranch_scc1 L_l0_130
    s_cmp_lg_u32 s38, 1
    s_cbranch_scc1 L_sb_131
    v_and_b32 v3, 7, v0
    v_lshlrev_b32 v3, 2, v3
    global_load_dword v148, v3, s[24:25] offset:32 sc1
L_sb_131:
L_l0_130:
    s_sleep 2
    s_cmp_lg_u32 s43, 0
    s_cbranch_scc1 L_l0_135
    s_sleep 4
L_l0_135:
    s_mov_b32 s65, 20000
    global_load_dwordx4 v[136:139], v6, s[34:35] sc1
    global_load_dwordx4 v[120:123], v5, s[34:35] offset:0 sc1
    global_load_dwordx4 v[124:127], v5, s[34:35] offset:1024 sc1
    global_load_dwordx4 v[140:143], v6, s[34:35] offset:512 sc1
    s_branch L_gh_133
L_gr_132:
    s_sub_u32 s65, s65, 1
    s_cbranch_scc1 L_gd_134
    global_load_dwordx4 v[136:139], v6, s[34:35] sc1
    global_load_dwordx4 v[120:123], v5, s[34:35] offset:0 sc1
    global_load_dwordx4 v[124:127], v5, s[34:35] offset:1024 sc1
    global_load_dwordx4 v[140:143], v6, s[34:35] offset:512 sc1
L_gh_133:
    s_waitcnt vmcnt(3)
    v_max3_f32 v144, v136, v137, v138
    v_max_f32 v144, v144, v139
    s_nop 1
    v_max_f32_dpp v144, v144, v144 row_ror:8 row_mask:0xf bank_mask:0xf
    s_nop 1
    v_max_f32_dpp v144, v144, v144 row_bcast:15 row_mask:0xa bank_mask:0xf
    s_nop 1
    v_max_f32_dpp v144, v144, v144 row_bcast:31 row_mask:0xc bank_mask:0xf
    s_nop 0
    v_readlane_b32 s52, v144, 63
    s_nop 1
    v_subrev_f32 v152, s52, v136
    v_subrev_f32 v153, s52, v137
    v_subrev_f32 v154, s52, v138
    v_subrev_f32 v155, s52, v139
    v_exp_f32 v152, v152
    v_exp_f32 v153, v153
    v_exp_f32 v154, v154
    v_exp_f32 v155, v155
    v_cvt_pk_bf16_f32 v132, v152, v153
    v_cvt_pk_bf16_f32 v133, v154, v155
    s_waitcnt vmcnt(2)
    v_dot2_f32_bf16 v144, v120, v132, 0
    v_dot2_f32_bf16 v145, v121, v132, 0
    v_dot2_f32_bf16 v146, v122, v132, 0
    v_dot2_f32_bf16 v147, v123, v132, 0
    s_waitcnt vmcnt(1)
    v_dot2_f32_bf16 v144, v124, v133, v144
    v_dot2_f32_bf16 v145, v125, v133, v145
    v_dot2_f32_bf16 v146, v126, v133, v146
    v_dot2_f32_bf16 v147, v127, v133, v147
    s_nop 1
    v_permlane32_swap_b32 v144, v146
    v_permlane32_swap_b32 v145, v147
    v_pk_add_f32 v[144:145], v[144:145], v[146:147]
    s_nop 1
    v_permlane16_swap_b32 v144, v145
    v_add_f32 v144, v144, v145
    s_nop 1
    v_add_f32_dpp v144, v144, v144 row_ror:8 row_mask:0xf bank_mask:0xf
    v_cvt_pk_bf16_f32 v145, v144, v144
    ds_write_b16 v11, v145 offset:256
    v_cmp_u_f32 vcc, v144, v144
    s_cbranch_vccnz L_gr_132
L_gd_134:
    s_cmp_lg_u32 s43, 0
    s_cbranch_scc1 L_l0_137
    s_mov_b32 s65, 20000
    s_waitcnt vmcnt(0)
L_ll_138:
    v_pk_mul_f32 v[146:147], v[152:153], v[140:141]
    v_pk_fma_f32 v[146:147], v[154:155], v[142:143], v[146:147]
    v_add_f32 v146, v146, v147
    v_cmp_u_f32 vcc, v146, v146
    s_cbranch_vccz L_lk_139
    s_sub_u32 s65, s65, 1
    s_cbranch_scc1 L_lk_139
    global_load_dwordx4 v[140:143], v6, s[34:35] offset:512 sc1
    s_waitcnt vmcnt(0)
    s_branch L_ll_138
L_lk_139:
    v_mov_b32 v28, 4972
    v_mov_b32 v29, 1
    s_mov_b64 exec, 1
    ds_add_u32 v28, v29
    s_mov_b64 exec, -1
    s_cmp_lg_u32 s38, 1
    s_cbranch_scc1 L_sb_140
    s_mov_b32 s65, 0x100000
L_f2_141:
    v_cmp_eq_u32 vcc, 0, v148
    s_cbranch_vccz L_sb_140
    s_sub_u32 s65, s65, 1
    s_cbranch_scc1 L_sb_140
    global_load_dword v148, v3, s[24:25] offset:32 sc1
    s_waitcnt vmcnt(0)
    s_branch L_f2_141
L_sb_140:
L_l0_137:
    s_cmp_lg_u32 s43, 0
    s_cbranch_scc1 L_sy_142
    v_mov_b32 v28, 4960
    v_mov_b32 v29, 1
    s_mov_b64 exec, 1
    ds_add_u32 v28, v29
    s_mov_b64 exec, -1
    v_mov_b32 v28, 4960
    s_mov_b32 s65, 0x100000
L_lw_144:
    s_sub_u32 s65, s65, 1
    s_cbranch_scc1 L_lwd_145
    ds_read_b32 v29, v28
    s_waitcnt lgkmcnt(0)
    v_readfirstlane_b32 s52, v29
    s_nop 0
    s_cmp_lg_u32 s52, 5
    s_cbranch_scc1 L_lw_144
L_lwd_145:
    s_branch L_sy_143
L_sy_142:
    s_waitcnt lgkmcnt(0)
    s_barrier
L_sy_143:
    s_cmp_lg_u32 s59, 0
    s_cbranch_scc1 L_wo_146
    ds_read_b64_tr_b16 v[32:33], v19 offset:24576
    ds_read_b64_tr_b16 v[34:35], v19 offset:25088
    ds_read_b64_tr_b16 v[36:37], v19 offset:28672
    ds_read_b64_tr_b16 v[38:39], v19 offset:29184
    ds_read_b64_tr_b16 v[40:41], v19 offset:32768
    ds_read_b64_tr_b16 v[42:43], v19 offset:33280
    ds_read_b64_tr_b16 v[44:45], v19 offset:36864
    ds_read_b64_tr_b16 v[46:47], v19 offset:37376
L_wo_146:
    ds_read_b128 v[124:127], v14 offset:256
    ds_read_b128 v[128:131], v14 offset:320
    ds_read_b128 v[132:135], v14 offset:384
    ds_read_b128 v[136:139], v14 offset:448
    s_mov_b32 s65, 20000
    s_waitcnt vmcnt(0)
L_ll_147:
    v_pk_mul_f32 v[146:147], v[152:153], v[140:141]
    v_pk_fma_f32 v[146:147], v[154:155], v[142:143], v[146:147]
    v_add_f32 v146, v146, v147
    v_cmp_u_f32 vcc, v146, v146
    s_cbranch_vccz L_lk_148
    s_sub_u32 s65, s65, 1
    s_cbranch_scc1 L_lk_148
    global_load_dwordx4 v[140:143], v6, s[34:35] offset:512 sc1
    s_waitcnt vmcnt(0)
    s_branch L_ll_147
L_lk_148:
    v_add_f32_dpp v146, v146, v146 row_ror:8 row_mask:0xf bank_mask:0xf
    s_nop 1
    v_add_f32_dpp v146, v146, v146 row_bcast:15 row_mask:0xa bank_mask:0xf
    s_nop 1
    v_add_f32_dpp v146, v146, v146 row_bcast:31 row_mask:0xc bank_mask:0xf
    s_nop 0
    v_readlane_b32 s52, v146, 63
    s_nop 1
    v_rcp_f32 v146, s52
    s_waitcnt lgkmcnt(3)
    v_mfma_f32_16x16x32_bf16 v[120:123], v[124:127], v[32:35], 0
    s_waitcnt lgkmcnt(2)
    v_mfma_f32_16x16x32_bf16 v[120:123], v[128:131], v[36:39], v[120:123]
    s_waitcnt lgkmcnt(1)
    v_mfma_f32_16x16x32_bf16 v[120:123], v[132:135], v[40:43], v[120:123]
    s_waitcnt lgkmcnt(0)
    v_mfma_f32_16x16x32_bf16 v[120:123], v[136:139], v[44:47], v[120:123]
    s_nop 7
    v_mul_f32 v120, v120, v146
    s_mov_b64 exec, 0xffff
    v_cvt_pk_bf16_f32 v120, v120, v120
    global_store_short v15, v120, s[40:41] sc1
    s_mov_b64 exec, -1
    s_cmp_lg_u32 s43, 0
    s_cbranch_scc1 L_l0_149
    v_add_u32 v3, 73728, v9
    global_load_dword v48, v10, s[34:35] offset:0
    global_load_dword v48, v9, s[34:35] offset:0
    global_load_dword v48, v9, s[34:35] offset:256
    global_load_dword v48, v3, s[34:35] offset:0
    global_load_dword v48, v3, s[34:35] offset:256
L_l0_149:
    s_sleep 13
    s_cmp_lg_u32 s43, 0
    s_cbranch_scc1 L_l0_153
    s_sleep 7
L_l0_153:
    s_mov_b32 s65, 20000
    s_cmp_lg_u32 s43, 0
    s_cbranch_scc1 L_l0_154
    v_add_u32 v3, 106496, v7
    global_load_dwordx4 v[148:151], v3, s[34:35] offset:-2304 sc1
    global_load_dwordx4 v[152:155], v3, s[34:35] offset:2304 sc1
L_l0_154:
    global_load_dwordx4 v[120:123], v5, s[40:41] offset:0
    global_load_dwordx4 v[124:127], v5, s[40:41] offset:1024
    s_branch L_gh_151
L_gr_150:
    s_sub_u32 s65, s65, 1
    s_cbranch_scc1 L_gd_152
    s_cmp_lg_u32 s43, 0
    s_cbranch_scc1 L_l0_156
    s_sleep 2
L_l0_156:
    global_load_dwordx4 v[120:123], v5, s[40:41] offset:0 sc1
    global_load_dwordx4 v[124:127], v5, s[40:41] offset:1024 sc1
L_gh_151:
    s_waitcnt vmcnt(1)
    v_dot2_f32_bf16 v136, v120, s42, 0
    v_dot2_f32_bf16 v137, v121, s42, 0
    v_dot2_f32_bf16 v138, v122, s42, 0
    v_dot2_f32_bf16 v139, v123, s42, 0
    s_waitcnt vmcnt(0)
    v_dot2_f32_bf16 v136, v124, s42, v136
    v_dot2_f32_bf16 v137, v125, s42, v137
    v_dot2_f32_bf16 v138, v126, s42, v138
    v_dot2_f32_bf16 v139, v127, s42, v139
    s_nop 1
    v_permlane32_swap_b32 v136, v138
    v_permlane32_swap_b32 v137, v139
    v_pk_add_f32 v[136:137], v[136:137], v[138:139]
    s_nop 1
    v_permlane16_swap_b32 v136, v137
    v_add_f32 v136, v136, v137
    s_nop 1
    v_add_f32_dpp v136, v136, v136 row_ror:8 row_mask:0xf bank_mask:0xf
    v_cvt_pk_bf16_f32 v137, v136, v136
    v_lshlrev_b32 v137, 16, v137
    v_add_f32 v137, v137, v24
    v_cvt_pk_bf16_f32 v137, v137, v137
    ds_write_b16 v11, v137 offset:512
    v_cmp_u_f32 vcc, v136, v136
    s_cbranch_vccnz L_gr_150
L_gd_152:
    v_lshlrev_b32 v24, 16, v137
    s_waitcnt lgkmcnt(0)
    s_barrier
    s_cmp_lg_u32 s38, 0
    s_cbranch_scc1 L_sb_157
    v_lshlrev_b32 v3, 2, v0
    ds_read_b32 v120, v3 offset:512
    s_lshl_b32 s52, s32, 5
    s_lshl_b32 s53, s33, 3
    s_add_u32 s52, s52, s53
    s_add_u32 s52, s52, 52480
    v_lshrrev_b32 v3, 5, v0
    v_lshl_add_u32 v3, v3, 2, s52
    s_mov_b32 s52, 0x3f803f80
    s_waitcnt lgkmcnt(0)
    v_dot2_f32_bf16 v121, v120, s52, 0
    v_dot2_f32_bf16 v122, v120, v120, 0
    s_nop 2
    v_permlane32_swap_b32 v121, v122
    v_add_f32 v121, v121, v122
    v_mov_b32 v122, v121
    s_nop 1
    v_permlane16_swap_b32 v121, v122
    v_add_f32 v121, v121, v122
    s_nop 1
    v_add_f32_dpp v121, v121, v121 quad_perm:[1,0,3,2] row_mask:0xf bank_mask:0xf
    s_nop 1
    v_add_f32_dpp v121, v121, v121 quad_perm:[2,3,0,1] row_mask:0xf bank_mask:0xf
    s_nop 1
    v_add_f32_dpp v121, v121, v121 row_half_mirror row_mask:0xf bank_mask:0xf
    s_nop 1
    v_add_f32_dpp v121, v121, v121 row_mirror row_mask:0xf bank_mask:0xf
    s_mov_b32 exec_lo, 1
    s_mov_b32 exec_hi, 1
    s_cmp_eq_u32 s31, 0
    s_cbranch_scc1 L_st_158
    global_store_dword v3, v121, s[34:35]
    s_branch L_st_159
L_st_158:
    global_store_dword v3, v121, s[34:35] sc1
L_st_159:
    s_mov_b64 exec, -1
L_sb_157:
    s_cmp_lt_u32 s28, 4
    s_cselect_b32 s52, 4, 3
    s_cmp_ge_u32 s38, s52
    s_cbranch_scc1 L_nd_160
    s_cmp_lg_u32 s43, 0
    s_cbranch_scc1 L_dn1_161
    v_add_u32 v3, 73728, v9
    s_sleep 6
    s_mov_b32 s65, 20000
    global_load_dwordx2 v[128:129], v10, s[34:35] sc1
    global_load_dword v122, v3, s[34:35] sc1
    global_load_dword v123, v3, s[34:35] offset:256 sc1
    global_load_dword v120, v9, s[34:35] sc1
    global_load_dword v121, v9, s[34:35] offset:256 sc1
    s_branch L_gh_164
L_gr_163:
    s_sub_u32 s65, s65, 1
    s_cbranch_scc1 L_gd_165
    global_load_dwordx2 v[128:129], v10, s[34:35] sc1
    global_load_dword v122, v3, s[34:35] sc1
    global_load_dword v123, v3, s[34:35] offset:256 sc1
    global_load_dword v120, v9, s[34:35] sc1
    global_load_dword v121, v9, s[34:35] offset:256 sc1
L_gh_164:
    s_waitcnt vmcnt(4)
    v_add_f32_dpp v128, v128, v128 quad_perm:[1,0,3,2] row_mask:0xf bank_mask:0xf
    v_add_f32_dpp v129, v129, v129 quad_perm:[1,0,3,2] row_mask:0xf bank_mask:0xf
    s_nop 0
    v_add_f32_dpp v128, v128, v128 quad_perm:[2,3,0,1] row_mask:0xf bank_mask:0xf
    v_add_f32_dpp v129, v129, v129 quad_perm:[2,3,0,1] row_mask:0xf bank_mask:0xf
    v_mov_b32 v131, v129
    v_mul_f32 v128, 0x3b000000, v128
    v_mul_f32 v129, 0x3b000000, v129
    v_fma_f32 v129, -v128, v128, v129
    v_max_f32 v129, 0, v129
    v_cvt_pk_bf16_f32 v130, v128, v129
    v_and_b32 v129, s45, v130
    v_add_f32 v129, 0x3727c5ac, v129
    v_lshlrev_b32 v128, 16, v130
    v_cvt_pk_bf16_f32 v129, v129, v129
    v_lshlrev_b32 v129, 16, v129
    v_sqrt_f32 v129, v129
    s_nop 0
    v_cvt_pk_bf16_f32 v129, v129, v129
    v_lshlrev_b32 v129, 16, v129
    v_rcp_f32 v129, v129
    s_waitcnt vmcnt(2)
    v_permlane32_swap_b32 v122, v123
    v_add_f32 v26, v122, v123
    v_mov_b32 v122, v26
    s_nop 1
    v_permlane16_swap_b32 v26, v122
    v_add_f32 v26, v26, v122
    s_waitcnt vmcnt(0)
    v_permlane32_swap_b32 v120, v121
    v_add_f32 v120, v120, v121
    v_mov_b32 v121, v120
    s_nop 1
    v_permlane16_swap_b32 v120, v121
    v_add_f32 v120, v120, v121
    v_fma_f32 v120, -v128, v26, v120
    v_mul_f32 v120, v120, v129
    v_cvt_pk_bf16_f32 v121, v120, v120
    v_lshlrev_b32 v121, 16, v121
    v_mov_b32 v122, v121
    s_nop 1
    v_permlane32_swap_b32 v121, v122
    v_mul_f32 v121, 0xbfb8aa3b, v121
    v_exp_f32 v121, v121
    s_nop 0
    v_add_f32 v121, 1.0, v121
    v_rcp_f32 v121, v121
    s_nop 0
    v_cvt_pk_bf16_f32 v121, v121, v121
    v_lshlrev_b32 v121, 16, v121
    v_mul_f32 v121, v121, v122
    v_cvt_pk_bf16_f32 v121, v121, v121
    ds_write_b16 v13, v121
    v_cmp_u_f32 vcc, v120, v131
    s_cbranch_vccnz L_gr_163
L_gd_165:
    s_branch L_dn2_162
L_dn1_161:
L_TP22:
    s_cbranch_execz L_TX22
    s_sleep 6
    s_mov_b32 s65, 20000
    global_load_dwordx2 v[128:129], v10, s[34:35] sc1
    global_load_dword v120, v9, s[34:35] sc1
    global_load_dword v121, v9, s[34:35] offset:256 sc1
    s_branch L_gh_168
L_gr_167:
L_TP23:
    s_cbranch_execz L_TX23
    s_sub_u32 s65, s65, 1
    s_cbranch_scc1 L_gd_169
    global_load_dwordx2 v[128:129], v10, s[34:35] sc1
    global_load_dword v120, v9, s[34:35] sc1
    global_load_dword v121, v9, s[34:35] offset:256 sc1
L_gh_168:
    s_waitcnt vmcnt(2)
    v_add_f32_dpp v128, v128, v128 quad_perm:[1,0,3,2] row_mask:0xf bank_mask:0xf
    v_add_f32_dpp v129, v129, v129 quad_perm:[1,0,3,2] row_mask:0xf bank_mask:0xf
    s_nop 0
    v_add_f32_dpp v128, v128, v128 quad_perm:[2,3,0,1] row_mask:0xf bank_mask:0xf
L_TP24:
    s_cbranch_execz L_TX24
    v_add_f32_dpp v129, v129, v129 quad_perm:[2,3,0,1] row_mask:0xf bank_mask:0xf
    v_mov_b32 v131, v129
    v_mul_f32 v128, 0x3b000000, v128
    v_mul_f32 v129, 0x3b000000, v129
    v_fma_f32 v129, -v128, v128, v129
    v_max_f32 v129, 0, v129
    v_cvt_pk_bf16_f32 v130, v128, v129
    v_and_b32 v129, s45, v130
    v_add_f32 v129, 0x3727c5ac, v129
L_TP25:
    s_cbranch_execz L_TX25
    v_lshlrev_b32 v128, 16, v130
    v_cvt_pk_bf16_f32 v129, v129, v129
    v_lshlrev_b32 v129, 16, v129
    v_sqrt_f32 v129, v129
    s_nop 0
    v_cvt_pk_bf16_f32 v129, v129, v129
    v_lshlrev_b32 v129, 16, v129
    v_rcp_f32 v129, v129
    s_waitcnt vmcnt(0)
    v_permlane32_swap_b32 v120, v121
    v_add_f32 v120, v120, v121
    v_mov_b32 v121, v120
L_TP26:
    s_cbranch_execz L_TX26
    s_nop 1
    v_permlane16_swap_b32 v120, v121
    v_add_f32 v120, v120, v121
    v_fma_f32 v120, -v128, v26, v120
    v_mul_f32 v120, v120, v129
    v_cvt_pk_bf16_f32 v121, v120, v120
    v_lshlrev_b32 v121, 16, v121
    v_mov_b32 v122, v121
    s_nop 1
    v_permlane32_swap_b32 v121, v122
    v_mul_f32 v121, 0xbfb8aa3b, v121
    v_exp_f32 v121, v121
L_TP27:
    s_cbranch_execz L_TX27
    s_nop 0
    v_add_f32 v121, 1.0, v121
    v_rcp_f32 v121, v121
    s_nop 0
    v_cvt_pk_bf16_f32 v121, v121, v121
    v_lshlrev_b32 v121, 16, v121
    v_mul_f32 v121, v121, v122
    v_cvt_pk_bf16_f32 v121, v121, v121
    ds_write_b16 v13, v121
    v_cmp_u_f32 vcc, v120, v131
    s_cbranch_vccnz L_gr_167
L_gd_169:
L_dn2_162:
L_nd_160:
    s_waitcnt lgkmcnt(0)
    s_barrier
    s_cmp_lg_u32 s43, 0
    s_cbranch_scc1 L_l0_171
    v_pk_add_f32 v[148:149], v[148:149], v[152:153]
    v_pk_add_f32 v[150:151], v[150:151], v[154:155]
    s_nop 1
    v_permlane32_swap_b32 v148, v150
    v_permlane32_swap_b32 v149, v151
    v_pk_add_f32 v[22:23], v[148:149], v[150:151]
    v_cmp_u_f32 vcc, v22, v23
    s_cbranch_vccz L_l0_171
    v_add_u32 v3, 106496, v7
    s_mov_b32 s65, 20000
    global_load_dwordx4 v[120:123], v3, s[34:35] offset:-2304 sc1
    global_load_dwordx4 v[124:127], v3, s[34:35] offset:2304 sc1
    s_branch L_gh_173
L_gr_172:
    s_sub_u32 s65, s65, 1
    s_cbranch_scc1 L_gd_174
    global_load_dwordx4 v[120:123], v3, s[34:35] offset:-2304 sc1
    global_load_dwordx4 v[124:127], v3, s[34:35] offset:2304 sc1
L_gh_173:
    s_waitcnt vmcnt(0)
    v_pk_add_f32 v[120:121], v[120:121], v[124:125]
    v_pk_add_f32 v[122:123], v[122:123], v[126:127]
    s_nop 1
    v_permlane32_swap_b32 v120, v122
    v_permlane32_swap_b32 v121, v123
    v_pk_add_f32 v[22:23], v[120:121], v[122:123]
    v_cmp_u_f32 vcc, v22, v23
    s_cbranch_vccnz L_gr_172
L_gd_174:
L_l0_171:
    s_add_u32 s43, s43, 1
    s_mov_b64 s[48:49], s[40:41]
    s_add_u32 s34, s34, 53248
    s_addc_u32 s35, s35, 0
    s_add_u32 s40, s40, 65536
    s_addc_u32 s41, s41, 0
    s_cmp_lt_u32 s43, 2
    s_cbranch_scc1 L_Gloop
L_TP28:
    s_cbranch_execz L_TX28
    s_or_b32 s52, s28, s32
    s_cmp_lg_u32 s52, 0
    s_cbranch_scc1 L_fin
    v_add_u32 v3, 32768, v5
    s_sleep 8
    s_mov_b32 s65, 20000
    global_load_dwordx4 v[120:123], v3, s[48:49] offset:0
    global_load_dwordx4 v[124:127], v3, s[48:49] offset:1024
L_TP29:
    s_cbranch_execz L_TX29
    s_branch L_gh_177
L_gr_176:
    s_sub_u32 s65, s65, 1
    s_cbranch_scc1 L_gd_178
    global_load_dwordx4 v[120:123], v3, s[48:49] offset:0 sc1
    global_load_dwordx4 v[124:127], v3, s[48:49] offset:1024 sc1
L_gh_177:
    s_waitcnt vmcnt(1)
    v_dot2_f32_bf16 v136, v120, s42, 0
    v_dot2_f32_bf16 v137, v121, s42, 0
    v_dot2_f32_bf16 v138, v122, s42, 0
    v_dot2_f32_bf16 v139, v123, s42, 0
L_TP30:
    s_cbranch_execz L_TX30
    s_waitcnt vmcnt(0)
    v_dot2_f32_bf16 v136, v124, s42, v136
    v_dot2_f32_bf16 v137, v125, s42, v137
    v_dot2_f32_bf16 v138, v126, s42, v138
    v_dot2_f32_bf16 v139, v127, s42, v139
    s_nop 1
    v_permlane32_swap_b32 v136, v138
    v_permlane32_swap_b32 v137, v139
    v_pk_add_f32 v[136:137], v[136:137], v[138:139]
L_TP31:
    s_cbranch_execz L_TX31
    s_nop 1
    v_permlane16_swap_b32 v136, v137
    v_add_f32 v136, v136, v137
    s_nop 1
    v_add_f32_dpp v136, v136, v136 row_ror:8 row_mask:0xf bank_mask:0xf
    v_cvt_pk_bf16_f32 v137, v136, v136
    v_lshlrev_b32 v137, 16, v137
    v_add_f32 v137, v137, v24
    v_cvt_pk_bf16_f32 v137, v137, v137
    v_cmp_u_f32 vcc, v136, v136
    s_cbranch_vccnz L_gr_176
L_gd_178:
    s_lshl_b32 s52, s33, 8
L_TP32:
    s_cbranch_execz L_TX32
    v_add_u32 v3, s52, v11
    s_mov_b32 exec_lo, 0x00ff00ff
    s_mov_b32 exec_hi, 0x00ff00ff
    global_store_short v3, v137, s[22:23] sc1
    s_or_b32 s52, s33, s38
    s_cmp_lg_u32 s52, 0
    s_cbranch_scc1 L_ep_180
    s_mov_b64 exec, 1
    v_mov_b32 v3, 0
    v_mov_b32 v4, s60
    global_store_dword v3, v4, s[26:27] sc1
L_ep_180:
    s_mov_b64 exec, -1
L_fin:
    s_endpgm
L_TENT:
    s_cmp_eq_u32 s52, 0
    s_cbranch_scc1 L_TP0
    s_cmp_eq_u32 s52, 1
    s_cbranch_scc1 L_TP4
    s_cmp_eq_u32 s52, 2
    s_cbranch_scc1 L_TP8
    s_cmp_eq_u32 s52, 3
    s_cbranch_scc1 L_TP12
    s_cmp_eq_u32 s52, 4
    s_cbranch_scc1 L_TP16
    s_cmp_eq_u32 s52, 5
    s_cbranch_scc1 L_TP20
    s_cmp_eq_u32 s52, 6
    s_cbranch_scc1 L_TP24
    s_cmp_eq_u32 s52, 7
    s_cbranch_scc1 L_TP28
    s_cmp_eq_u32 s52, 8
    s_cbranch_scc1 L_TP1
    s_cmp_eq_u32 s52, 9
    s_cbranch_scc1 L_TP5
    s_cmp_eq_u32 s52, 10
    s_cbranch_scc1 L_TP9
    s_cmp_eq_u32 s52, 11
    s_cbranch_scc1 L_TP13
    s_cmp_eq_u32 s52, 12
    s_cbranch_scc1 L_TP17
    s_cmp_eq_u32 s52, 13
    s_cbranch_scc1 L_TP21
    s_cmp_eq_u32 s52, 14
    s_cbranch_scc1 L_TP25
    s_cmp_eq_u32 s52, 15
    s_cbranch_scc1 L_TP29
    s_cmp_eq_u32 s52, 16
    s_cbranch_scc1 L_TP2
    s_cmp_eq_u32 s52, 17
    s_cbranch_scc1 L_TP6
    s_cmp_eq_u32 s52, 18
    s_cbranch_scc1 L_TP10
    s_cmp_eq_u32 s52, 19
    s_cbranch_scc1 L_TP14
    s_cmp_eq_u32 s52, 20
    s_cbranch_scc1 L_TP18
    s_cmp_eq_u32 s52, 21
    s_cbranch_scc1 L_TP22
    s_cmp_eq_u32 s52, 22
    s_cbranch_scc1 L_TP26
    s_cmp_eq_u32 s52, 23
    s_cbranch_scc1 L_TP30
    s_cmp_eq_u32 s52, 24
    s_cbranch_scc1 L_TP3
    s_cmp_eq_u32 s52, 25
    s_cbranch_scc1 L_TP7
    s_cmp_eq_u32 s52, 26
    s_cbranch_scc1 L_TP11
    s_cmp_eq_u32 s52, 27
    s_cbranch_scc1 L_TP15
    s_cmp_eq_u32 s52, 28
    s_cbranch_scc1 L_TP19
    s_cmp_eq_u32 s52, 29
    s_cbranch_scc1 L_TP23
    s_cmp_eq_u32 s52, 30
    s_cbranch_scc1 L_TP27
    s_cmp_eq_u32 s52, 31
    s_cbranch_scc1 L_TP31
L_TRET:
    s_cmp_eq_u32 s98, 0
    s_cbranch_scc1 L_TRET0
    s_branch L_TRET1
L_TX0:
    s_sub_u32 s53, s53, 1
    s_cbranch_scc1 L_TRET
    s_branch L_TP4
L_TX4:
    s_sub_u32 s53, s53, 1
    s_cbranch_scc1 L_TRET
    s_branch L_TP8
L_TX8:
    s_sub_u32 s53, s53, 1
    s_cbranch_scc1 L_TRET
    s_branch L_TP12
L_TX12:
    s_sub_u32 s53, s53, 1
    s_cbranch_scc1 L_TRET
    s_branch L_TP16
L_TX16:
    s_sub_u32 s53, s53, 1
    s_cbranch_scc1 L_TRET
    s_branch L_TP20
L_TX20:
    s_sub_u32 s53, s53, 1
    s_cbranch_scc1 L_TRET
    s_branch L_TP24
L_TX24:
    s_sub_u32 s53, s53, 1
    s_cbranch_scc1 L_TRET
    s_branch L_TP28
L_TX28:
    s_sub_u32 s53, s53, 1
    s_cbranch_scc1 L_TRET
    s_branch L_TP32
L_TX32:
    s_sub_u32 s53, s53, 1
    s_cbranch_scc1 L_TRET
    s_branch L_TP0
L_TX1:
    s_sub_u32 s53, s53, 1
    s_cbranch_scc1 L_TRET
    s_branch L_TP5
L_TX5:
    s_sub_u32 s53, s53, 1
    s_cbranch_scc1 L_TRET
    s_branch L_TP9
L_TX9:
    s_sub_u32 s53, s53, 1
    s_cbranch_scc1 L_TRET
    s_branch L_TP13
L_TX13:
    s_sub_u32 s53, s53, 1
    s_cbranch_scc1 L_TRET
    s_branch L_TP17
L_TX17:
    s_sub_u32 s53, s53, 1
    s_cbranch_scc1 L_TRET
    s_branch L_TP21
L_TX21:
    s_sub_u32 s53, s53, 1
    s_cbranch_scc1 L_TRET
    s_branch L_TP25
L_TX25:
    s_sub_u32 s53, s53, 1
    s_cbranch_scc1 L_TRET
    s_branch L_TP29
L_TX29:
    s_sub_u32 s53, s53, 1
    s_cbranch_scc1 L_TRET
    s_branch L_TP1
L_TX2:
    s_sub_u32 s53, s53, 1
    s_cbranch_scc1 L_TRET
    s_branch L_TP6
L_TX6:
    s_sub_u32 s53, s53, 1
    s_cbranch_scc1 L_TRET
    s_branch L_TP10
L_TX10:
    s_sub_u32 s53, s53, 1
    s_cbranch_scc1 L_TRET
    s_branch L_TP14
L_TX14:
    s_sub_u32 s53, s53, 1
    s_cbranch_scc1 L_TRET
    s_branch L_TP18
L_TX18:
    s_sub_u32 s53, s53, 1
    s_cbranch_scc1 L_TRET
    s_branch L_TP22
L_TX22:
    s_sub_u32 s53, s53, 1
    s_cbranch_scc1 L_TRET
    s_branch L_TP26
L_TX26:
    s_sub_u32 s53, s53, 1
    s_cbranch_scc1 L_TRET
    s_branch L_TP30
L_TX30:
    s_sub_u32 s53, s53, 1
    s_cbranch_scc1 L_TRET
    s_branch L_TP2
L_TX3:
    s_sub_u32 s53, s53, 1
    s_cbranch_scc1 L_TRET
    s_branch L_TP7
L_TX7:
    s_sub_u32 s53, s53, 1
    s_cbranch_scc1 L_TRET
    s_branch L_TP11
L_TX11:
    s_sub_u32 s53, s53, 1
    s_cbranch_scc1 L_TRET
    s_branch L_TP15
L_TX15:
    s_sub_u32 s53, s53, 1
    s_cbranch_scc1 L_TRET
    s_branch L_TP19
L_TX19:
    s_sub_u32 s53, s53, 1
    s_cbranch_scc1 L_TRET
    s_branch L_TP23
L_TX23:
    s_sub_u32 s53, s53, 1
    s_cbranch_scc1 L_TRET
    s_branch L_TP27
L_TX27:
    s_sub_u32 s53, s53, 1
    s_cbranch_scc1 L_TRET
    s_branch L_TP31
L_TX31:
    s_sub_u32 s53, s53, 1
    s_cbranch_scc1 L_TRET
    s_branch L_TP3
L_end:
    s_endpgm
.section .rodata,"a"
.p2align 6
.amdhsa_kernel interleave_layers__sliding_block_cached__glu_gated_glu__decode_kernel
  .amdhsa_next_free_vgpr 160
  .amdhsa_next_free_sgpr 100
  .amdhsa_accum_offset 160
  .amdhsa_group_segment_fixed_size 0
  .amdhsa_kernarg_size 96
  .amdhsa_user_sgpr_count 2
  .amdhsa_user_sgpr_kernarg_segment_ptr 1
  .amdhsa_system_sgpr_workgroup_id_x 1
.end_amdhsa_kernel
```
